```python
import torch

def _softmax(x, axis=-1):
    return torch.softmax(x, dim=axis)
def _gelu(x):
    return torch.nn.functional.gelu(x, approximate="tanh")
def _silu(x):
    return torch.nn.functional.silu(x)
def _sigmoid(x):
    return torch.sigmoid(x)
def _layernorm(x, axis=-1, eps=1e-5):
    m = x.mean(dim=axis, keepdim=True)
    v = x.var(dim=axis, keepdim=True, unbiased=False)
    return (x - m) / torch.sqrt(v + eps)
def _scatter_add(tgt, idx, src, axis=0):
    return tgt.clone().index_add_(axis, idx, src)
def _segment_sum(src, seg, n):
    out = torch.zeros((n,) + src.shape[1:], dtype=src.dtype)
    return out.index_add_(0, seg, src)
def _pad(x, pw):
    flat = tuple(v for pair in reversed(pw) for v in pair)
    return torch.nn.functional.pad(x, flat)

kernel_name = 'standalone__linear_kernel_performer__prompt'

def setup_inputs():

    _w = (lambda a: (lambda t: t.to(torch.bfloat16) if t.is_floating_point() else t)(torch.as_tensor(a)))
    B, H, S, D = 1, 32, 2048, 192
    M = D
    return {
        "q": _w((lambda *s: torch.randn(*s, dtype=torch.bfloat16) * 0.05)(B, H, S, D)),
        "k": _w((lambda *s: torch.randn(*s, dtype=torch.bfloat16) * 1.6)(B, H, S, D)),
        "v": _w((lambda *s: torch.randn(*s, dtype=torch.bfloat16) * 1.6)(B, H, S, D)),
        "proj": _w((lambda *s: torch.randn(*s, dtype=torch.bfloat16) * 1.6)(M, D)),
    }

def reference(q, k, v, proj):
    B, H, S, D = q.shape
    M = proj.shape[0]
    scale = D ** -0.25
    qs = q * scale
    ks = k * scale
    qw = torch.einsum("bhsd,md->bhsm", qs, proj)
    kw = torch.einsum("bhsd,md->bhsm", ks, proj)
    qn = torch.einsum("bhsd,bhsd->bhs", qs, qs)[..., None] * 0.5
    kn = torch.einsum("bhsd,bhsd->bhs", ks, ks)[..., None] * 0.5
    inv_sqrt_m = M ** -0.5
    phi_q = torch.exp(qw - qn) * inv_sqrt_m
    phi_k = torch.exp(kw - kn) * inv_sqrt_m
    kv = torch.einsum("bhsm,bhsd->bhmd", phi_k, v)
    ksum = torch.einsum("bhsm->bhm", phi_k)
    num = torch.einsum("bhsm,bhmd->bhsd", phi_q, kv)
    den = torch.einsum("bhsm,bhm->bhs", phi_q, ksum)[..., None] + 1e-6
    return num / den
```

```asm
; @launch grid=(256,1,1) block=(256,1,1) lds=160768
.amdgcn_target "amdgcn-amd-amdhsa--gfx950"
.text
.globl standalone__linear_kernel_performer__prompt_kernel
.p2align 8
.type standalone__linear_kernel_performer__prompt_kernel,@function
standalone__linear_kernel_performer__prompt_kernel:
L_START:
    s_cmp_ge_u32 s2, 256
    s_cbranch_scc1 L_END
    s_load_dwordx2 s[4:5], s[0:1], 8
    s_load_dwordx2 s[12:13], s[0:1], 24
    s_load_dwordx2 s[8:9], s[0:1], 16
    s_load_dwordx2 s[20:21], s[0:1], 0
    s_load_dwordx2 s[56:57], s[0:1], 32
    s_load_dwordx4 s[28:31], s[0:1], 40
    s_and_b32 s25, s2, 7
    s_lshr_b32 s26, s2, 3
    s_and_b32 s27, s26, 3
    s_lshl_b32 s25, s25, 2
    s_add_u32 s25, s25, s27
    s_lshr_b32 s26, s26, 2
    s_lshr_b32 s32, s26, 1
    s_and_b32 s33, s26, 1
    s_mul_i32 s22, s25, 786432
    s_mul_i32 s23, s32, 196608
    s_add_u32 s23, s23, s22
    s_mul_i32 s27, s26, 98304
    s_add_u32 s27, s27, s22
    s_getpc_b64 s[58:59]
L_PC:
    s_sub_u32 s58, s58, L_PC-L_START
    s_subb_u32 s59, s59, 0
    v_lshlrev_b32 v255, 7, v0
    v_min_u32 v255, L_END-L_START, v255
    global_load_dword v254, v255, s[58:59]
    v_lshrrev_b32 v22, 6, v0
    v_and_b32 v1, 63, v0
    v_readfirstlane_b32 s24, v22
    v_lshrrev_b32 v23, 4, v1
    v_lshrrev_b32 v21, 3, v1
    v_mul_u32_u24 v2, 384, v21
    v_mov_b32 v3, v2
    s_lshr_b32 s34, s24, 1
    s_and_b32 s35, s24, 1
    s_lshl_b32 s36, s35, 2
    v_add_u32 v21, s36, v23
    v_and_b32 v20, 7, v1
    v_xor_b32 v21, v21, v20
    v_lshl_add_u32 v2, v21, 4, v2
    s_mul_i32 s39, s24, 3072
    s_mul_i32 s38, s33, 24576
    s_waitcnt lgkmcnt(0)
    s_add_u32 s4, s4, s23
    s_addc_u32 s5, s5, 0
    s_mov_b32 s6, 196608
    s_mov_b32 s7, 0x00020000
    s_mov_b32 s14, 73728
    s_mov_b32 s15, 0x00020000
    s_lshl_b32 s41, s25, 9
    s_add_u32 s41, s41, 50331648
    s_add_u32 s64, s30, s41
    s_addc_u32 s65, s31, 0
    s_or_b32 s41, s26, s24
    s_cmp_lg_u32 s41, 0
    s_cbranch_scc1 L_NOINIT
    v_lshlrev_b32 v22, 7, v1
    v_mov_b32 v21, 0
    s_mov_b64 exec, 7
    global_store_dword v22, v21, s[64:65] sc1
    s_mov_b64 exec, -1
L_NOINIT:
    s_add_u32 s41, s39, 0
    s_add_u32 s42, s39, 0
    s_mov_b32 m0, s42
    s_nop 0
    buffer_load_dwordx4 v2, s[4:7], s41 offen offset:0 nt lds
    s_add_u32 m0, m0, 896
    s_nop 0
    buffer_load_dwordx4 v2, s[4:7], s41 offen offset:128 nt lds
    s_add_u32 m0, m0, 896
    s_nop 0
    buffer_load_dwordx4 v2, s[4:7], s41 offen offset:256 nt lds
    s_add_u32 s44, s41, 12288
    s_add_u32 m0, s42, 12288
    s_nop 0
    buffer_load_dwordx4 v2, s[4:7], s44 offen offset:0 nt lds
    s_add_u32 m0, m0, 896
    s_nop 0
    buffer_load_dwordx4 v2, s[4:7], s44 offen offset:128 nt lds
    s_add_u32 m0, m0, 896
    s_nop 0
    buffer_load_dwordx4 v2, s[4:7], s44 offen offset:256 nt lds
    s_mul_i32 s41, s33, 36864
    s_add_u32 s41, s41, s39
    s_add_u32 s43, s41, 0
    s_add_u32 m0, s39, 122880
    s_nop 0
    buffer_load_dwordx4 v2, s[12:15], s43 offen offset:0 lds
    s_add_u32 m0, m0, 896
    s_nop 0
    buffer_load_dwordx4 v2, s[12:15], s43 offen offset:128 lds
    s_add_u32 m0, m0, 896
    s_nop 0
    buffer_load_dwordx4 v2, s[12:15], s43 offen offset:256 lds
    s_add_u32 s43, s41, 12288
    s_add_u32 m0, s39, 135168
    s_nop 0
    buffer_load_dwordx4 v2, s[12:15], s43 offen offset:0 lds
    s_add_u32 m0, m0, 896
    s_nop 0
    buffer_load_dwordx4 v2, s[12:15], s43 offen offset:128 lds
    s_add_u32 m0, m0, 896
    s_nop 0
    buffer_load_dwordx4 v2, s[12:15], s43 offen offset:256 lds
    s_add_u32 s43, s41, 24576
    s_add_u32 m0, s39, 147456
    s_nop 0
    buffer_load_dwordx4 v2, s[12:15], s43 offen offset:0 lds
    s_add_u32 m0, m0, 896
    s_nop 0
    buffer_load_dwordx4 v2, s[12:15], s43 offen offset:128 lds
    s_add_u32 m0, m0, 896
    s_nop 0
    buffer_load_dwordx4 v2, s[12:15], s43 offen offset:256 lds
    v_bfe_u32 v21, v1, 1, 2
    v_xor_b32 v21, v21, v23
    v_lshl_add_u32 v3, v21, 5, v3
    v_and_b32 v21, 1, v1
    v_lshl_add_u32 v3, v21, 4, v3
    s_add_u32 s8, s8, s23
    s_addc_u32 s9, s9, 0
    s_mov_b32 s10, 196608
    s_mov_b32 s11, 0x00020000
    s_add_u32 s41, s39, 24576
    s_add_u32 s42, s39, 24576
    s_mov_b32 m0, s42
    s_nop 0
    buffer_load_dwordx4 v2, s[4:7], s41 offen offset:0 nt lds
    s_add_u32 m0, m0, 896
    s_nop 0
    buffer_load_dwordx4 v2, s[4:7], s41 offen offset:128 nt lds
    s_add_u32 m0, m0, 896
    s_nop 0
    buffer_load_dwordx4 v2, s[4:7], s41 offen offset:256 nt lds
    s_add_u32 s44, s41, 12288
    s_add_u32 m0, s42, 12288
    s_nop 0
    buffer_load_dwordx4 v2, s[4:7], s44 offen offset:0 nt lds
    s_add_u32 m0, m0, 896
    s_nop 0
    buffer_load_dwordx4 v2, s[4:7], s44 offen offset:128 nt lds
    s_add_u32 m0, m0, 896
    s_nop 0
    buffer_load_dwordx4 v2, s[4:7], s44 offen offset:256 nt lds
    s_add_u32 s41, s39, 0
    s_add_u32 s42, s39, 73728
    s_mov_b32 m0, s42
    s_nop 0
    buffer_load_dwordx4 v3, s[8:11], s41 offen offset:0 nt lds
    s_add_u32 m0, m0, 896
    s_nop 0
    buffer_load_dwordx4 v3, s[8:11], s41 offen offset:128 nt lds
    s_add_u32 m0, m0, 896
    s_nop 0
    buffer_load_dwordx4 v3, s[8:11], s41 offen offset:256 nt lds
    s_add_u32 s44, s41, 12288
    s_add_u32 m0, s42, 12288
    s_nop 0
    buffer_load_dwordx4 v3, s[8:11], s44 offen offset:0 nt lds
    s_add_u32 m0, m0, 896
    s_nop 0
    buffer_load_dwordx4 v3, s[8:11], s44 offen offset:128 nt lds
    s_add_u32 m0, m0, 896
    s_nop 0
    buffer_load_dwordx4 v3, s[8:11], s44 offen offset:256 nt lds
    v_and_b32 v22, 15, v1
    v_lshrrev_b32 v21, 3, v22
    v_mul_u32_u24 v4, 3072, v21
    v_and_b32 v21, 7, v22
    v_lshl_add_u32 v4, v21, 7, v4
    v_lshrrev_b32 v21, 1, v22
    v_xor_b32 v21, v21, v23
    v_lshl_add_u32 v4, v21, 4, v4
    v_xor_b32 v5, 64, v4
    v_lshrrev_b32 v21, 1, v23
    v_mul_u32_u24 v6, 3072, v21
    v_bfe_u32 v21, v1, 2, 3
    v_lshl_add_u32 v6, v21, 7, v6
    v_and_b32 v20, 3, v1
    v_lshl_add_u32 v6, v20, 3, v6
    v_lshrrev_b32 v21, 1, v21
    s_mul_i32 s36, s24, 3
    s_add_u32 s37, s36, 2
    s_and_b32 s22, s37, 3
    s_lshr_b32 s37, s37, 2
    s_lshl_b32 s37, s37, 10
    s_add_u32 s37, s37, 73728
    v_xor_b32 v20, s22, v21
    v_lshlrev_b32 v20, 5, v20
    v_add_u32 v20, s37, v20
    v_add_u32 v13, v20, v6
    s_add_u32 s37, s36, 1
    s_and_b32 s22, s37, 3
    s_lshr_b32 s37, s37, 2
    s_lshl_b32 s37, s37, 10
    s_add_u32 s37, s37, 73728
    v_xor_b32 v20, s22, v21
    v_lshlrev_b32 v20, 5, v20
    v_add_u32 v20, s37, v20
    v_add_u32 v7, v20, v6
    s_add_u32 s37, s36, 0
    s_and_b32 s22, s37, 3
    s_lshr_b32 s37, s37, 2
    s_lshl_b32 s37, s37, 10
    s_add_u32 s37, s37, 73728
    v_xor_b32 v20, s22, v21
    v_lshlrev_b32 v20, 5, v20
    v_add_u32 v20, s37, v20
    v_add_u32 v6, v20, v6
    s_mul_i32 s37, s34, 12288
    s_lshl_b32 s36, s24, 7
    s_add_u32 s36, s36, 159744
    v_lshlrev_b32 v18, 4, v23
    v_add_u32 v18, s36, v18
    v_lshlrev_b32 v19, 2, v22
    v_add_u32 v19, s36, v19
    v_lshlrev_b32 v20, 4, v1
    v_mul_u32_u24 v21, 384, v22
    v_and_b32 v22, 1, v23
    v_lshl_add_u32 v21, v22, 5, v21
    v_lshrrev_b32 v22, 1, v23
    v_lshl_add_u32 v21, v22, 4, v21
    s_add_u32 s41, s39, 147456
    v_add_u32 v8, s41, v20
    v_add_u32 v9, 147456, v20
    v_mov_b32 v188, 0x3f803f80
    v_mov_b32 v189, 0x3f803f80
    v_mov_b32 v190, 0x3f803f80
    v_mov_b32 v191, 0x3f803f80
    v_mov_b32 v236, 0
    v_mov_b32 v237, 0
    v_mov_b32 v238, 0
    v_mov_b32 v239, 0
    v_mov_b32 v240, 0
    v_mov_b32 v241, 0
    v_mov_b32 v242, 0
    v_mov_b32 v243, 0
    v_and_b32 v22, 15, v1
    v_lshrrev_b32 v23, 4, v1
    v_lshlrev_b32 v23, 2, v23
    v_sub_u32 v22, v22, v23
    v_cmp_eq_u32 vcc, 0, v22
    v_mov_b32 v23, 0x3d553b95
    s_nop 0
    v_cndmask_b32 v200, 0, v23, vcc
    v_cmp_eq_u32 vcc, 1, v22
    v_mov_b32 v23, 0x3d553b95
    s_nop 0
    v_cndmask_b32 v201, 0, v23, vcc
    v_cmp_eq_u32 vcc, 2, v22
    v_mov_b32 v23, 0x3d553b95
    s_nop 0
    v_cndmask_b32 v202, 0, v23, vcc
    v_cmp_eq_u32 vcc, 3, v22
    v_mov_b32 v23, 0x3d553b95
    s_nop 0
    v_cndmask_b32 v203, 0, v23, vcc
    v_lshrrev_b32 v23, 4, v1
    v_and_b32 v22, 15, v1
    v_mov_b32 v244, 0x3f803f80
    v_mov_b32 v245, 0
    v_mov_b32 v246, 0
    v_mov_b32 v247, 0
    v_mov_b32 v248, 0x4072b803
    v_mov_b32 v249, 0x4072b803
    v_mov_b32 v250, 0x4072b803
    v_mov_b32 v251, 0x4072b803
    s_mov_b32 s40, 0x3ec66f78
    s_add_u32 s20, s20, s27
    s_addc_u32 s21, s21, 0
    s_add_u32 s56, s56, s27
    s_addc_u32 s57, s57, 0
    s_mov_b32 s58, 98304
    s_mov_b32 s59, 0x00020000
    s_lshl_b32 s41, s33, 2
    s_add_u32 s41, s41, s32
    s_lshl_b32 s42, s25, 3
    s_add_u32 s41, s41, s42
    s_mul_i32 s41, s41, 37888
    s_add_u32 s16, s30, s41
    s_addc_u32 s17, s31, 0
    s_mov_b32 s18, 37888
    s_mov_b32 s19, 0x00020000
    s_lshl_b32 s62, s33, 7
    s_lshl_b32 s41, s24, 1
    s_add_u32 s41, s41, 0
    s_cmp_ge_u32 s41, 3
    s_cselect_b32 s42, 9, 0
    s_add_u32 s43, s41, s42
    s_cmp_ge_u32 s41, 6
    s_cselect_b32 s42, 9, 0
    s_add_u32 s43, s43, s42
    s_mul_i32 s42, s32, 3
    s_add_u32 s43, s43, s42
    s_lshl_b32 s66, s43, 10
    s_lshl_b32 s41, s24, 1
    s_add_u32 s41, s41, 1
    s_cmp_ge_u32 s41, 3
    s_cselect_b32 s42, 9, 0
    s_add_u32 s43, s41, s42
    s_cmp_ge_u32 s41, 6
    s_cselect_b32 s42, 9, 0
    s_add_u32 s43, s43, s42
    s_mul_i32 s42, s32, 3
    s_add_u32 s43, s43, s42
    s_lshl_b32 s67, s43, 10
    s_mul_i32 s42, s32, 3
    s_add_u32 s42, s42, 26
    s_lshl_b32 s68, s42, 10
    s_lshl_b32 s41, s24, 8
    s_add_u32 s68, s68, s41
    v_mov_b32 v208, -1
    v_mov_b32 v209, -1
    v_mov_b32 v210, -1
    v_mov_b32 v211, -1
    v_accvgpr_write_b32 a0, 0
    v_accvgpr_write_b32 a1, 0
    v_accvgpr_write_b32 a2, 0
    v_accvgpr_write_b32 a3, 0
    v_accvgpr_write_b32 a4, 0
    v_accvgpr_write_b32 a5, 0
    v_accvgpr_write_b32 a6, 0
    v_accvgpr_write_b32 a7, 0
    v_accvgpr_write_b32 a8, 0
    v_accvgpr_write_b32 a9, 0
    v_accvgpr_write_b32 a10, 0
    v_accvgpr_write_b32 a11, 0
    v_accvgpr_write_b32 a12, 0
    v_accvgpr_write_b32 a13, 0
    v_accvgpr_write_b32 a14, 0
    v_accvgpr_write_b32 a15, 0
    v_accvgpr_write_b32 a16, 0
    v_accvgpr_write_b32 a17, 0
    v_accvgpr_write_b32 a18, 0
    v_accvgpr_write_b32 a19, 0
    v_accvgpr_write_b32 a20, 0
    v_accvgpr_write_b32 a21, 0
    v_accvgpr_write_b32 a22, 0
    v_accvgpr_write_b32 a23, 0
    v_accvgpr_write_b32 a24, 0
    v_accvgpr_write_b32 a25, 0
    v_accvgpr_write_b32 a26, 0
    v_accvgpr_write_b32 a27, 0
    v_accvgpr_write_b32 a28, 0
    v_accvgpr_write_b32 a29, 0
    v_accvgpr_write_b32 a30, 0
    v_accvgpr_write_b32 a31, 0
    v_accvgpr_write_b32 a32, 0
    v_accvgpr_write_b32 a33, 0
    v_accvgpr_write_b32 a34, 0
    v_accvgpr_write_b32 a35, 0
    v_accvgpr_write_b32 a36, 0
    v_accvgpr_write_b32 a37, 0
    v_accvgpr_write_b32 a38, 0
    v_accvgpr_write_b32 a39, 0
    v_accvgpr_write_b32 a40, 0
    v_accvgpr_write_b32 a41, 0
    v_accvgpr_write_b32 a42, 0
    v_accvgpr_write_b32 a43, 0
    v_accvgpr_write_b32 a44, 0
    v_accvgpr_write_b32 a45, 0
    v_accvgpr_write_b32 a46, 0
    v_accvgpr_write_b32 a47, 0
    v_accvgpr_write_b32 a48, 0
    v_accvgpr_write_b32 a49, 0
    v_accvgpr_write_b32 a50, 0
    v_accvgpr_write_b32 a51, 0
    v_accvgpr_write_b32 a52, 0
    v_accvgpr_write_b32 a53, 0
    v_accvgpr_write_b32 a54, 0
    v_accvgpr_write_b32 a55, 0
    v_accvgpr_write_b32 a56, 0
    v_accvgpr_write_b32 a57, 0
    v_accvgpr_write_b32 a58, 0
    v_accvgpr_write_b32 a59, 0
    v_accvgpr_write_b32 a60, 0
    v_accvgpr_write_b32 a61, 0
    v_accvgpr_write_b32 a62, 0
    v_accvgpr_write_b32 a63, 0
    v_accvgpr_write_b32 a64, 0
    v_accvgpr_write_b32 a65, 0
    v_accvgpr_write_b32 a66, 0
    v_accvgpr_write_b32 a67, 0
    v_accvgpr_write_b32 a68, 0
    v_accvgpr_write_b32 a69, 0
    v_accvgpr_write_b32 a70, 0
    v_accvgpr_write_b32 a71, 0
    v_accvgpr_write_b32 a72, 0
    v_accvgpr_write_b32 a73, 0
    v_accvgpr_write_b32 a74, 0
    v_accvgpr_write_b32 a75, 0
    v_accvgpr_write_b32 a76, 0
    v_accvgpr_write_b32 a77, 0
    v_accvgpr_write_b32 a78, 0
    v_accvgpr_write_b32 a79, 0
    v_accvgpr_write_b32 a80, 0
    v_accvgpr_write_b32 a81, 0
    v_accvgpr_write_b32 a82, 0
    v_accvgpr_write_b32 a83, 0
    v_mov_b32 v176, 0
    v_mov_b32 v177, 0
    v_mov_b32 v178, 0
    v_mov_b32 v179, 0
    v_mov_b32 v180, 0
    v_mov_b32 v181, 0
    v_mov_b32 v182, 0
    v_mov_b32 v183, 0
    v_mov_b32 v184, 0
    v_mov_b32 v185, 0
    v_mov_b32 v186, 0
    v_mov_b32 v187, 0
    s_waitcnt vmcnt(12)
    s_or_b32 s41, s26, s24
    s_cmp_eq_u32 s41, 0
    s_cselect_b32 s63, 3, 99
    s_mul_i32 s41, s25, 73728
    s_mul_i32 s42, s33, 36864
    s_add_u32 s41, s41, s42
    s_add_u32 s41, s41, 33554432
    s_add_u32 s26, s30, s41
    s_addc_u32 s27, s31, 0
    s_barrier
    s_mul_i32 s41, s35, 18432
    s_add_u32 s41, s41, 122880
    v_add_u32 v10, s41, v4
    v_add_u32 v11, s41, v5
    ds_read_b128 a[84:87], v10 offset:0
    ds_read_b128 a[88:91], v11 offset:0
    ds_read_b128 a[92:95], v10 offset:1024
    ds_read_b128 a[96:99], v11 offset:1024
    ds_read_b128 a[100:103], v10 offset:2048
    ds_read_b128 a[104:107], v11 offset:2048
    s_mul_i32 s41, s35, 18432
    s_add_u32 s41, s41, 129024
    v_add_u32 v10, s41, v4
    v_add_u32 v11, s41, v5
    ds_read_b128 a[108:111], v10 offset:0
    ds_read_b128 a[112:115], v11 offset:0
    ds_read_b128 a[116:119], v10 offset:1024
    ds_read_b128 a[120:123], v11 offset:1024
    ds_read_b128 a[124:127], v10 offset:2048
    ds_read_b128 a[128:131], v11 offset:2048
    s_mul_i32 s41, s35, 18432
    s_add_u32 s41, s41, 135168
    v_add_u32 v10, s41, v4
    v_add_u32 v11, s41, v5
    ds_read_b128 a[132:135], v10 offset:0
    ds_read_b128 a[136:139], v11 offset:0
    ds_read_b128 a[140:143], v10 offset:1024
    ds_read_b128 a[144:147], v11 offset:1024
    ds_read_b128 a[148:151], v10 offset:2048
    ds_read_b128 a[152:155], v11 offset:2048
    s_add_u32 s55, s37, 0
    v_add_u32 v10, s55, v4
    v_add_u32 v11, s55, v5
    ds_read_b128 v[24:27], v10 offset:0
    ds_read_b128 v[28:31], v10 offset:6144
    ds_read_b128 v[32:35], v11 offset:0
    ds_read_b128 v[36:39], v11 offset:6144
    ds_read_b128 v[40:43], v10 offset:1024
    ds_read_b128 v[44:47], v10 offset:7168
    ds_read_b128 v[48:51], v11 offset:1024
    ds_read_b128 v[52:55], v11 offset:7168
    ds_read_b128 v[56:59], v10 offset:2048
    ds_read_b128 v[60:63], v10 offset:8192
    ds_read_b128 v[64:67], v11 offset:2048
    ds_read_b128 v[68:71], v11 offset:8192
    s_add_u32 s41, s39, 49152
    s_add_u32 s42, s39, 49152
    s_mov_b32 m0, s42
    s_nop 0
    buffer_load_dwordx4 v2, s[4:7], s41 offen offset:0 nt lds
    s_add_u32 m0, m0, 896
    s_nop 0
    buffer_load_dwordx4 v2, s[4:7], s41 offen offset:128 nt lds
    s_add_u32 m0, m0, 896
    s_nop 0
    buffer_load_dwordx4 v2, s[4:7], s41 offen offset:256 nt lds
    s_add_u32 s44, s41, 12288
    s_add_u32 m0, s42, 12288
    s_nop 0
    buffer_load_dwordx4 v2, s[4:7], s44 offen offset:0 nt lds
    s_add_u32 m0, m0, 896
    s_nop 0
    buffer_load_dwordx4 v2, s[4:7], s44 offen offset:128 nt lds
    s_add_u32 m0, m0, 896
    s_nop 0
    buffer_load_dwordx4 v2, s[4:7], s44 offen offset:256 nt lds
    s_add_u32 s41, s39, 24576
    s_add_u32 s42, s39, 98304
    s_mov_b32 m0, s42
    s_nop 0
    buffer_load_dwordx4 v3, s[8:11], s41 offen offset:0 nt lds
    s_add_u32 m0, m0, 896
    s_nop 0
    buffer_load_dwordx4 v3, s[8:11], s41 offen offset:128 nt lds
    s_add_u32 m0, m0, 896
    s_nop 0
    buffer_load_dwordx4 v3, s[8:11], s41 offen offset:256 nt lds
    s_add_u32 s44, s41, 12288
    s_add_u32 m0, s42, 12288
    s_nop 0
    buffer_load_dwordx4 v3, s[8:11], s44 offen offset:0 nt lds
    s_add_u32 m0, m0, 896
    s_nop 0
    buffer_load_dwordx4 v3, s[8:11], s44 offen offset:128 nt lds
    s_add_u32 m0, m0, 896
    s_nop 0
    buffer_load_dwordx4 v3, s[8:11], s44 offen offset:256 nt lds
    s_waitcnt lgkmcnt(0)
    s_barrier
    ds_write_b128 v8, v[176:179] offset:0
    ds_write_b128 v8, v[180:183] offset:1024
    ds_write_b128 v8, v[184:187] offset:2048
    s_mov_b32 s50, 0
    s_add_u32 s51, s39, 73728
    s_add_u32 s53, s39, 49152
    s_mov_b32 s38, 0
    s_mov_b32 s52, 0
    s_mov_b32 s54, 24576
    s_mov_b32 s55, 49152
    s_add_u32 s60, s39, 0
    s_add_u32 s61, s39, 12288
    s_add_u32 s48, s39, 73728
    s_add_u32 s49, s39, 86016
    s_add_u32 s41, s37, 0
    v_add_u32 v16, s41, v4
    v_add_u32 v17, s41, v5
    v_add_u32 v10, s54, v16
    v_add_u32 v11, s54, v17
    v_subrev_u32 v232, 73728, v6
    v_subrev_u32 v233, 73728, v7
    v_subrev_u32 v234, 73728, v13
    v_mov_b32 v12, v3
    v_mfma_f32_16x16x32_bf16 v[192:195], v[24:27], v[24:27], 0
    v_mfma_f32_16x16x32_bf16 v[196:199], v[28:31], v[28:31], 0
    v_mfma_f32_16x16x32_bf16 v[192:195], v[32:35], v[32:35], v[192:195]
    v_mfma_f32_16x16x32_bf16 v[196:199], v[36:39], v[36:39], v[196:199]
    v_mfma_f32_16x16x32_bf16 v[192:195], v[40:43], v[40:43], v[192:195]
    v_mfma_f32_16x16x32_bf16 v[196:199], v[44:47], v[44:47], v[196:199]
    v_mfma_f32_16x16x32_bf16 v[192:195], v[48:51], v[48:51], v[192:195]
    v_mfma_f32_16x16x32_bf16 v[196:199], v[52:55], v[52:55], v[196:199]
    v_mfma_f32_16x16x32_bf16 v[192:195], v[56:59], v[56:59], v[192:195]
    v_mfma_f32_16x16x32_bf16 v[196:199], v[60:63], v[60:63], v[196:199]
    v_mfma_f32_16x16x32_bf16 v[192:195], v[64:67], v[64:67], v[192:195]
    v_mfma_f32_16x16x32_bf16 v[196:199], v[68:71], v[68:71], v[196:199]
L_LOOP:
    s_waitcnt vmcnt(24) lgkmcnt(0)
    s_barrier
    v_mfma_f32_16x16x32_bf16 a[72:75], v[176:179], v[188:191], a[72:75]
    s_nop 3
    v_mul_f32 v204, v192, v200
    v_mul_f32 v205, v196, v200
    v_mfma_f32_16x16x32_bf16 a[76:79], v[180:183], v[188:191], a[76:79]
    v_fmac_f32 v204, v193, v201
    v_fmac_f32 v205, v197, v201
    v_mfma_f32_16x16x32_bf16 a[80:83], v[184:187], v[188:191], a[80:83]
    v_fmac_f32 v204, v194, v202
    v_fmac_f32 v205, v198, v202
    v_mfma_f32_16x16x32_bf16 v[144:147], v[24:27], a[84:87], 0
    v_fmac_f32 v204, v195, v203
    v_fmac_f32 v205, v199, v203
    v_mfma_f32_16x16x32_bf16 v[156:159], v[28:31], a[84:87], 0
    v_and_b32 v206, 0xffff0000, v204
    v_and_b32 v207, 0xffff0000, v205
    v_mfma_f32_16x16x32_bf16 v[144:147], v[32:35], a[88:91], v[144:147]
    v_sub_f32 v204, v204, v206
    v_sub_f32 v205, v205, v207
    v_mfma_f32_16x16x32_bf16 v[156:159], v[36:39], a[88:91], v[156:159]
    v_cvt_pk_bf16_f32 v236, v206, v204
    v_cvt_pk_bf16_f32 v240, v207, v205
    v_mfma_f32_16x16x32_bf16 v[144:147], v[40:43], a[92:95], v[144:147]
    ds_read_b64_tr_b16 v[72:73], v232 offset:0
    v_mfma_f32_16x16x32_bf16 v[156:159], v[44:47], a[92:95], v[156:159]
    s_add_u32 m0, s52, s60
    ds_read_b64_tr_b16 v[74:75], v232 offset:6144
    v_mfma_f32_16x16x32_bf16 v[168:171], v[236:239], v[244:247], v[248:251]
    buffer_load_dwordx4 v2, s[4:7], s51 offen offset:0 nt lds
    ds_read_b64_tr_b16 v[76:77], v233 offset:0
    v_mfma_f32_16x16x32_bf16 v[172:175], v[240:243], v[244:247], v[248:251]
    s_add_u32 m0, m0, 896
    ds_read_b64_tr_b16 v[78:79], v233 offset:6144
    v_mfma_f32_16x16x32_bf16 v[144:147], v[48:51], a[96:99], v[144:147]
    buffer_load_dwordx4 v2, s[4:7], s51 offen offset:128 nt lds
    ds_read_b64_tr_b16 v[80:81], v234 offset:0
    v_mfma_f32_16x16x32_bf16 v[156:159], v[52:55], a[96:99], v[156:159]
    s_add_u32 m0, m0, 896
    ds_read_b64_tr_b16 v[82:83], v234 offset:6144
    v_mfma_f32_16x16x32_bf16 v[144:147], v[56:59], a[100:103], v[144:147]
    buffer_load_dwordx4 v2, s[4:7], s51 offen offset:256 nt lds
    ds_read_b128 v[96:99], v9 offset:0
    v_mfma_f32_16x16x32_bf16 v[156:159], v[60:63], a[100:103], v[156:159]
    s_add_u32 s44, s51, 12288
    ds_read_b128 v[100:103], v9 offset:1024
    v_mfma_f32_16x16x32_bf16 v[144:147], v[64:67], a[104:107], v[144:147]
    s_add_u32 m0, s52, s61
    ds_read_b128 v[104:107], v9 offset:2048
    v_mfma_f32_16x16x32_bf16 v[156:159], v[68:71], a[104:107], v[156:159]
    buffer_load_dwordx4 v2, s[4:7], s44 offen offset:0 nt lds
    ds_read_b128 v[108:111], v9 offset:3072
    v_mfma_f32_16x16x32_bf16 v[148:151], v[24:27], a[108:111], 0
    s_add_u32 m0, m0, 896
    ds_read_b128 v[112:115], v9 offset:4096
    v_fma_f32 v144, v144, s40, -v168
    v_mfma_f32_16x16x32_bf16 v[160:163], v[28:31], a[108:111], 0
    buffer_load_dwordx4 v2, s[4:7], s44 offen offset:128 nt lds
    v_fma_f32 v145, v145, s40, -v169
    v_mfma_f32_16x16x32_bf16 v[148:151], v[32:35], a[112:115], v[148:151]
    ds_read_b128 v[116:119], v9 offset:5120
    v_fma_f32 v146, v146, s40, -v170
    v_mfma_f32_16x16x32_bf16 v[160:163], v[36:39], a[112:115], v[160:163]
    s_add_u32 m0, m0, 896
    ds_read_b64_tr_b16 v[84:85], v232 offset:12288
    v_fma_f32 v147, v147, s40, -v171
    v_mfma_f32_16x16x32_bf16 v[148:151], v[40:43], a[116:119], v[148:151]
    buffer_load_dwordx4 v2, s[4:7], s44 offen offset:256 nt lds
    v_fma_f32 v156, v156, s40, -v172
    v_mfma_f32_16x16x32_bf16 v[160:163], v[44:47], a[116:119], v[160:163]
    ds_read_b64_tr_b16 v[86:87], v232 offset:18432
    v_fma_f32 v157, v157, s40, -v173
    v_mfma_f32_16x16x32_bf16 v[148:151], v[48:51], a[120:123], v[148:151]
    ds_read_b64_tr_b16 v[88:89], v233 offset:12288
    v_fma_f32 v158, v158, s40, -v174
    v_mfma_f32_16x16x32_bf16 v[160:163], v[52:55], a[120:123], v[160:163]
    ds_read_b64_tr_b16 v[90:91], v233 offset:18432
    v_fma_f32 v159, v159, s40, -v175
    v_mfma_f32_16x16x32_bf16 v[148:151], v[56:59], a[124:127], v[148:151]
    v_exp_f32 v144, v144
    v_mfma_f32_16x16x32_bf16 v[160:163], v[60:63], a[124:127], v[160:163]
    v_exp_f32 v145, v145
    v_mfma_f32_16x16x32_bf16 v[148:151], v[64:67], a[128:131], v[148:151]
    v_exp_f32 v146, v146
    v_mfma_f32_16x16x32_bf16 v[160:163], v[68:71], a[128:131], v[160:163]
    v_exp_f32 v147, v147
    v_mfma_f32_16x16x32_bf16 v[152:155], v[24:27], a[132:135], 0
    v_exp_f32 v156, v156
    v_mfma_f32_16x16x32_bf16 v[164:167], v[28:31], a[132:135], 0
    v_exp_f32 v157, v157
    v_mfma_f32_16x16x32_bf16 v[152:155], v[32:35], a[136:139], v[152:155]
    v_exp_f32 v158, v158
    v_mfma_f32_16x16x32_bf16 v[164:167], v[36:39], a[136:139], v[164:167]
    v_exp_f32 v159, v159
    v_mfma_f32_16x16x32_bf16 v[152:155], v[40:43], a[140:143], v[152:155]
    ds_read_b64_tr_b16 v[92:93], v234 offset:12288
    v_cvt_pk_bf16_f32 v176, v144, v145
    v_mfma_f32_16x16x32_bf16 v[164:167], v[44:47], a[140:143], v[164:167]
    ds_read_b64_tr_b16 v[94:95], v234 offset:18432
    v_cvt_pk_bf16_f32 v177, v146, v147
    v_mfma_f32_16x16x32_bf16 v[152:155], v[48:51], a[144:147], v[152:155]
    ds_read_b128 v[120:123], v9 offset:6144
    v_cvt_pk_bf16_f32 v178, v156, v157
    v_mfma_f32_16x16x32_bf16 v[164:167], v[52:55], a[144:147], v[164:167]
    ds_read_b128 v[124:127], v9 offset:7168
    v_cvt_pk_bf16_f32 v179, v158, v159
    v_mfma_f32_16x16x32_bf16 v[152:155], v[56:59], a[148:151], v[152:155]
    ds_read_b128 v[128:131], v9 offset:8192
    v_fma_f32 v148, v148, s40, -v168
    v_mfma_f32_16x16x32_bf16 v[164:167], v[60:63], a[148:151], v[164:167]
    ds_read_b128 v[132:135], v9 offset:9216
    v_fma_f32 v149, v149, s40, -v169
    v_mfma_f32_16x16x32_bf16 v[152:155], v[64:67], a[152:155], v[152:155]
    ds_read_b128 v[136:139], v9 offset:10240
    v_fma_f32 v150, v150, s40, -v170
    v_mfma_f32_16x16x32_bf16 v[164:167], v[68:71], a[152:155], v[164:167]
    ds_read_b128 v[140:143], v9 offset:11264
    v_fma_f32 v151, v151, s40, -v171
    v_fma_f32 v160, v160, s40, -v172
    v_fma_f32 v161, v161, s40, -v173
    v_fma_f32 v162, v162, s40, -v174
    v_fma_f32 v163, v163, s40, -v175
    s_waitcnt vmcnt(24) lgkmcnt(0)
    s_barrier
    s_cmp_lg_u32 s50, s63
    s_cbranch_scc1 L_NOINIT2
    s_lshl_b32 s41, s25, 2
    v_mov_b32 v22, s41
    v_mov_b32 v235, 1
    s_mov_b64 exec, 1
    global_store_dword v22, v235, s[28:29] offset:128 sc1
    s_mov_b64 exec, -1
L_NOINIT2:
    s_cmp_lg_u32 s50, 1
    s_cbranch_scc1 L_NOSENT
    v_add_u32 v22, s66, v20
    global_store_dwordx4 v22, v[208:211], s[26:27] sc1
    v_add_u32 v22, s67, v20
    global_store_dwordx4 v22, v[208:211], s[26:27] sc1
    v_add_u32 v22, s68, v20
    s_mov_b64 exec, 0xffff
    global_store_dwordx4 v22, v[208:211], s[26:27] sc1
    s_mov_b64 exec, -1
    v_lshrrev_b32 v22, 4, v1
    v_lshlrev_b32 v22, 4, v22
    s_mul_i32 s45, s24, 192
    s_add_u32 s45, s45, 36864
    s_mov_b32 s46, 0x00010001
    s_mov_b32 s47, 0x00010001
    s_mov_b64 exec, s[46:47]
    buffer_store_dwordx4 v[208:211], v22, s[16:19], s45 offen offset:0 sc1
    buffer_store_dwordx4 v[208:211], v22, s[16:19], s45 offen offset:64 sc1
    buffer_store_dwordx4 v[208:211], v22, s[16:19], s45 offen offset:128 sc1
    s_mov_b64 exec, -1
L_NOSENT:
    v_mfma_f32_16x16x32_bf16 a[0:3], v[96:99], v[72:75], a[0:3]
    v_exp_f32 v148, v148
    v_mfma_f32_16x16x32_bf16 a[4:7], v[96:99], v[76:79], a[4:7]
    v_exp_f32 v149, v149
    v_mfma_f32_16x16x32_bf16 a[8:11], v[96:99], v[80:83], a[8:11]
    v_exp_f32 v150, v150
    v_mfma_f32_16x16x32_bf16 a[12:15], v[100:103], v[72:75], a[12:15]
    v_exp_f32 v151, v151
    v_mfma_f32_16x16x32_bf16 a[16:19], v[100:103], v[76:79], a[16:19]
    v_exp_f32 v160, v160
    v_mfma_f32_16x16x32_bf16 a[20:23], v[100:103], v[80:83], a[20:23]
    v_exp_f32 v161, v161
    v_mfma_f32_16x16x32_bf16 a[24:27], v[104:107], v[72:75], a[24:27]
    v_exp_f32 v162, v162
    v_mfma_f32_16x16x32_bf16 a[28:31], v[104:107], v[76:79], a[28:31]
    v_exp_f32 v163, v163
    v_mfma_f32_16x16x32_bf16 a[32:35], v[104:107], v[80:83], a[32:35]
    ds_write_b128 v8, v[176:179] offset:0
    v_cvt_pk_bf16_f32 v180, v148, v149
    v_mfma_f32_16x16x32_bf16 a[36:39], v[108:111], v[72:75], a[36:39]
    ds_read_b128 v[24:27], v10 offset:0
    v_cvt_pk_bf16_f32 v181, v150, v151
    v_mfma_f32_16x16x32_bf16 a[40:43], v[108:111], v[76:79], a[40:43]
    s_add_u32 m0, s55, s48
    ds_read_b128 v[28:31], v10 offset:6144
    v_cvt_pk_bf16_f32 v182, v160, v161
    v_mfma_f32_16x16x32_bf16 a[44:47], v[108:111], v[80:83], a[44:47]
    buffer_load_dwordx4 v12, s[8:11], s53 offen offset:0 nt lds
    v_cvt_pk_bf16_f32 v183, v162, v163
    v_mfma_f32_16x16x32_bf16 a[48:51], v[112:115], v[72:75], a[48:51]
    ds_read_b128 v[32:35], v11 offset:0
    ds_write_b128 v8, v[180:183] offset:1024
    v_mfma_f32_16x16x32_bf16 a[52:55], v[112:115], v[76:79], a[52:55]
    s_add_u32 m0, m0, 896
    ds_read_b128 v[36:39], v11 offset:6144
    v_fma_f32 v152, v152, s40, -v168
    v_mfma_f32_16x16x32_bf16 a[56:59], v[112:115], v[80:83], a[56:59]
    buffer_load_dwordx4 v12, s[8:11], s53 offen offset:128 nt lds
    v_fma_f32 v153, v153, s40, -v169
    v_mfma_f32_16x16x32_bf16 a[60:63], v[116:119], v[72:75], a[60:63]
    ds_read_b128 v[40:43], v10 offset:1024
    v_fma_f32 v154, v154, s40, -v170
    v_mfma_f32_16x16x32_bf16 a[64:67], v[116:119], v[76:79], a[64:67]
    ds_read_b128 v[44:47], v10 offset:7168
    v_fma_f32 v155, v155, s40, -v171
    v_mfma_f32_16x16x32_bf16 a[68:71], v[116:119], v[80:83], a[68:71]
    ds_read_b128 v[48:51], v11 offset:1024
    v_fma_f32 v164, v164, s40, -v172
    v_mfma_f32_16x16x32_bf16 a[0:3], v[120:123], v[84:87], a[0:3]
    ds_read_b128 v[52:55], v11 offset:7168
    v_fma_f32 v165, v165, s40, -v173
    v_mfma_f32_16x16x32_bf16 a[4:7], v[120:123], v[88:91], a[4:7]
    ds_read_b128 v[56:59], v10 offset:2048
    v_fma_f32 v166, v166, s40, -v174
    v_mfma_f32_16x16x32_bf16 a[8:11], v[120:123], v[92:95], a[8:11]
    ds_read_b128 v[60:63], v10 offset:8192
    v_fma_f32 v167, v167, s40, -v175
    v_mfma_f32_16x16x32_bf16 a[12:15], v[124:127], v[84:87], a[12:15]
    v_exp_f32 v152, v152
    v_mfma_f32_16x16x32_bf16 a[16:19], v[124:127], v[88:91], a[16:19]
    v_exp_f32 v153, v153
    v_mfma_f32_16x16x32_bf16 a[20:23], v[124:127], v[92:95], a[20:23]
    v_exp_f32 v154, v154
    v_mfma_f32_16x16x32_bf16 a[24:27], v[128:131], v[84:87], a[24:27]
    v_exp_f32 v155, v155
    v_mfma_f32_16x16x32_bf16 a[28:31], v[128:131], v[88:91], a[28:31]
    v_exp_f32 v164, v164
    v_mfma_f32_16x16x32_bf16 a[32:35], v[128:131], v[92:95], a[32:35]
    v_exp_f32 v165, v165
    v_mfma_f32_16x16x32_bf16 a[36:39], v[132:135], v[84:87], a[36:39]
    v_exp_f32 v166, v166
    v_mfma_f32_16x16x32_bf16 a[40:43], v[132:135], v[88:91], a[40:43]
    v_exp_f32 v167, v167
    v_mfma_f32_16x16x32_bf16 a[44:47], v[132:135], v[92:95], a[44:47]
    ds_read_b128 v[64:67], v11 offset:2048
    v_cvt_pk_bf16_f32 v184, v152, v153
    v_mfma_f32_16x16x32_bf16 a[48:51], v[136:139], v[84:87], a[48:51]
    ds_read_b128 v[68:71], v11 offset:8192
    v_cvt_pk_bf16_f32 v185, v154, v155
    v_mfma_f32_16x16x32_bf16 a[52:55], v[136:139], v[88:91], a[52:55]
    s_add_u32 m0, m0, 896
    v_cvt_pk_bf16_f32 v186, v164, v165
    v_cvt_pk_bf16_f32 v187, v166, v167
    v_mfma_f32_16x16x32_bf16 a[56:59], v[136:139], v[92:95], a[56:59]
    buffer_load_dwordx4 v12, s[8:11], s53 offen offset:256 nt lds
    ds_write_b128 v8, v[184:187] offset:2048
    v_mfma_f32_16x16x32_bf16 a[60:63], v[140:143], v[84:87], a[60:63]
    s_add_u32 s45, s53, 12288
    s_add_u32 m0, s55, s49
    v_mfma_f32_16x16x32_bf16 a[64:67], v[140:143], v[88:91], a[64:67]
    buffer_load_dwordx4 v12, s[8:11], s45 offen offset:0 nt lds
    s_add_u32 m0, m0, 896
    v_mfma_f32_16x16x32_bf16 a[68:71], v[140:143], v[92:95], a[68:71]
    buffer_load_dwordx4 v12, s[8:11], s45 offen offset:128 nt lds
    s_add_u32 m0, m0, 896
    s_nop 0
    buffer_load_dwordx4 v12, s[8:11], s45 offen offset:256 nt lds
    s_waitcnt lgkmcnt(1)
    v_mfma_f32_16x16x32_bf16 v[192:195], v[24:27], v[24:27], 0
    s_add_u32 s50, s50, 1
    s_mov_b32 s46, s52
    s_mov_b32 s52, s54
    v_mfma_f32_16x16x32_bf16 v[196:199], v[28:31], v[28:31], 0
    s_mov_b32 s54, s55
    s_mov_b32 s55, s46
    s_add_u32 s51, s51, 24576
    v_mfma_f32_16x16x32_bf16 v[192:195], v[32:35], v[32:35], v[192:195]
    s_add_u32 s51, s51, s38
    s_add_u32 s46, s52, s39
    s_cmp_ge_u32 s50, 5
    v_mfma_f32_16x16x32_bf16 v[196:199], v[36:39], v[36:39], v[196:199]
    s_cselect_b32 s4, s12, s4
    s_cselect_b32 s5, s13, s5
    s_cselect_b32 s6, s14, s6
    v_mfma_f32_16x16x32_bf16 v[192:195], v[40:43], v[40:43], v[192:195]
    s_cselect_b32 s51, s46, s51
    s_add_u32 s53, s53, 24576
    s_sub_u32 s53, s53, s38
    v_mfma_f32_16x16x32_bf16 v[196:199], v[44:47], v[44:47], v[196:199]
    s_sub_u32 s38, 0, s38
    s_cmp_eq_u32 s50, 6
    s_cselect_b32 s8, s20, s8
    v_mfma_f32_16x16x32_bf16 v[192:195], v[48:51], v[48:51], v[192:195]
    s_cselect_b32 s9, s21, s9
    s_cselect_b32 s53, s39, s53
    s_cselect_b64 vcc, -1, 0
    v_mfma_f32_16x16x32_bf16 v[196:199], v[52:55], v[52:55], v[196:199]
    s_add_u32 s46, s39, 24576
    s_cmp_eq_u32 s50, 7
    s_cselect_b32 s53, s46, s53
    v_mfma_f32_16x16x32_bf16 v[192:195], v[56:59], v[56:59], v[192:195]
    v_cndmask_b32 v12, v12, v2, vcc
    v_add_u32 v10, s54, v16
    v_mfma_f32_16x16x32_bf16 v[196:199], v[60:63], v[60:63], v[196:199]
    v_add_u32 v11, s54, v17
    v_add_u32 v232, s55, v6
    v_mfma_f32_16x16x32_bf16 v[192:195], v[64:67], v[64:67], v[192:195]
    v_add_u32 v233, s55, v7
    v_add_u32 v234, s55, v13
    v_mfma_f32_16x16x32_bf16 v[196:199], v[68:71], v[68:71], v[196:199]
    s_cmp_lt_u32 s50, 8
    s_cbranch_scc1 L_LOOP
    s_waitcnt vmcnt(24) lgkmcnt(0)
    s_barrier
    s_lshl_b32 s41, s25, 2
    v_mov_b32 v253, s41
    global_load_dword v252, v253, s[28:29] offset:128 sc1
    ds_read_b64_tr_b16 v[72:73], v232 offset:0
    ds_read_b64_tr_b16 v[74:75], v232 offset:6144
    ds_read_b64_tr_b16 v[76:77], v233 offset:0
    ds_read_b64_tr_b16 v[78:79], v233 offset:6144
    ds_read_b64_tr_b16 v[80:81], v234 offset:0
    ds_read_b64_tr_b16 v[82:83], v234 offset:6144
    ds_read_b64_tr_b16 v[84:85], v232 offset:12288
    ds_read_b64_tr_b16 v[86:87], v232 offset:18432
    ds_read_b64_tr_b16 v[88:89], v233 offset:12288
    ds_read_b64_tr_b16 v[90:91], v233 offset:18432
    ds_read_b64_tr_b16 v[92:93], v234 offset:12288
    ds_read_b64_tr_b16 v[94:95], v234 offset:18432
    ds_read_b128 v[96:99], v9 offset:0
    ds_read_b128 v[120:123], v9 offset:6144
    ds_read_b128 v[100:103], v9 offset:1024
    ds_read_b128 v[124:127], v9 offset:7168
    ds_read_b128 v[104:107], v9 offset:2048
    ds_read_b128 v[128:131], v9 offset:8192
    ds_read_b128 v[108:111], v9 offset:3072
    ds_read_b128 v[132:135], v9 offset:9216
    ds_read_b128 v[112:115], v9 offset:4096
    ds_read_b128 v[136:139], v9 offset:10240
    ds_read_b128 v[116:119], v9 offset:5120
    ds_read_b128 v[140:143], v9 offset:11264
    v_mfma_f32_16x16x32_bf16 a[72:75], v[176:179], v[188:191], a[72:75]
    v_mfma_f32_16x16x32_bf16 a[76:79], v[180:183], v[188:191], a[76:79]
    v_mfma_f32_16x16x32_bf16 a[80:83], v[184:187], v[188:191], a[80:83]
    s_mul_i32 s43, s24, 3072
    v_add_u32 v14, 147456, v20
    s_waitcnt lgkmcnt(11)
    v_mfma_f32_16x16x32_bf16 a[0:3], v[96:99], v[72:75], a[0:3]
    v_mfma_f32_16x16x32_bf16 a[4:7], v[96:99], v[76:79], a[4:7]
    v_mfma_f32_16x16x32_bf16 a[8:11], v[96:99], v[80:83], a[8:11]
    s_waitcnt lgkmcnt(10)
    v_mfma_f32_16x16x32_bf16 a[0:3], v[120:123], v[84:87], a[0:3]
    v_mfma_f32_16x16x32_bf16 a[4:7], v[120:123], v[88:91], a[4:7]
    v_mfma_f32_16x16x32_bf16 a[8:11], v[120:123], v[92:95], a[8:11]
    s_waitcnt lgkmcnt(9)
    v_mfma_f32_16x16x32_bf16 a[12:15], v[100:103], v[72:75], a[12:15]
    v_mfma_f32_16x16x32_bf16 a[16:19], v[100:103], v[76:79], a[16:19]
    v_mfma_f32_16x16x32_bf16 a[20:23], v[100:103], v[80:83], a[20:23]
    s_waitcnt lgkmcnt(8)
    v_mfma_f32_16x16x32_bf16 a[12:15], v[124:127], v[84:87], a[12:15]
    v_mfma_f32_16x16x32_bf16 a[16:19], v[124:127], v[88:91], a[16:19]
    v_mfma_f32_16x16x32_bf16 a[20:23], v[124:127], v[92:95], a[20:23]
    s_waitcnt lgkmcnt(0)
    s_barrier
    v_mfma_f32_16x16x32_bf16 a[24:27], v[104:107], v[72:75], a[24:27]
    v_accvgpr_read_b32 v208, a0
    v_accvgpr_read_b32 v209, a1
    v_mfma_f32_16x16x32_bf16 a[28:31], v[104:107], v[76:79], a[28:31]
    v_accvgpr_read_b32 v210, a2
    v_accvgpr_read_b32 v211, a3
    v_mfma_f32_16x16x32_bf16 a[32:35], v[104:107], v[80:83], a[32:35]
    v_accvgpr_read_b32 v212, a12
    v_accvgpr_read_b32 v213, a13
    v_mfma_f32_16x16x32_bf16 a[24:27], v[128:131], v[84:87], a[24:27]
    v_accvgpr_read_b32 v214, a14
    v_accvgpr_read_b32 v215, a15
    v_mfma_f32_16x16x32_bf16 a[28:31], v[128:131], v[88:91], a[28:31]
    v_cvt_pk_bf16_f32 v216, v208, v209
    v_cvt_pk_bf16_f32 v217, v210, v211
    v_mfma_f32_16x16x32_bf16 a[32:35], v[128:131], v[92:95], a[32:35]
    v_cvt_pk_bf16_f32 v218, v212, v213
    v_cvt_pk_bf16_f32 v219, v214, v215
    v_mfma_f32_16x16x32_bf16 a[36:39], v[108:111], v[72:75], a[36:39]
    s_cmp_eq_u32 s24, s32
    s_cbranch_scc1 L_OWN0
    s_add_u32 s45, s43, 0
    buffer_store_dwordx4 v[216:219], v20, s[16:19], s45 offen sc1
    s_branch L_OWD0
L_OWN0:
    ds_write_b128 v14, v[216:219] offset:0
L_OWD0:
    v_accvgpr_read_b32 v220, a4
    v_mfma_f32_16x16x32_bf16 a[40:43], v[108:111], v[76:79], a[40:43]
    v_accvgpr_read_b32 v221, a5
    v_accvgpr_read_b32 v222, a6
    v_mfma_f32_16x16x32_bf16 a[44:47], v[108:111], v[80:83], a[44:47]
    v_accvgpr_read_b32 v223, a7
    v_accvgpr_read_b32 v224, a16
    v_mfma_f32_16x16x32_bf16 a[36:39], v[132:135], v[84:87], a[36:39]
    v_accvgpr_read_b32 v225, a17
    v_accvgpr_read_b32 v226, a18
    v_mfma_f32_16x16x32_bf16 a[40:43], v[132:135], v[88:91], a[40:43]
    v_accvgpr_read_b32 v227, a19
    v_cvt_pk_bf16_f32 v228, v220, v221
    v_mfma_f32_16x16x32_bf16 a[44:47], v[132:135], v[92:95], a[44:47]
    v_cvt_pk_bf16_f32 v229, v222, v223
    v_cvt_pk_bf16_f32 v230, v224, v225
    v_cvt_pk_bf16_f32 v231, v226, v227
    s_cmp_eq_u32 s24, s32
    s_cbranch_scc1 L_OWN1
    s_add_u32 s45, s43, 1024
    buffer_store_dwordx4 v[228:231], v20, s[16:19], s45 offen sc1
    s_branch L_OWD1
L_OWN1:
    ds_write_b128 v14, v[228:231] offset:1024
L_OWD1:
    v_accvgpr_read_b32 v208, a8
    v_accvgpr_read_b32 v209, a9
    v_accvgpr_read_b32 v210, a10
    v_accvgpr_read_b32 v211, a11
    v_accvgpr_read_b32 v212, a20
    v_accvgpr_read_b32 v213, a21
    v_accvgpr_read_b32 v214, a22
    v_accvgpr_read_b32 v215, a23
    v_cvt_pk_bf16_f32 v216, v208, v209
    v_cvt_pk_bf16_f32 v217, v210, v211
    v_cvt_pk_bf16_f32 v218, v212, v213
    v_cvt_pk_bf16_f32 v219, v214, v215
    s_cmp_eq_u32 s24, s32
    s_cbranch_scc1 L_OWN2
    s_add_u32 s45, s43, 2048
    buffer_store_dwordx4 v[216:219], v20, s[16:19], s45 offen sc1
    s_branch L_OWD2
L_OWN2:
    ds_write_b128 v14, v[216:219] offset:2048
L_OWD2:
    v_mfma_f32_16x16x32_bf16 a[48:51], v[112:115], v[72:75], a[48:51]
    v_accvgpr_read_b32 v220, a24
    v_accvgpr_read_b32 v221, a25
    v_mfma_f32_16x16x32_bf16 a[52:55], v[112:115], v[76:79], a[52:55]
    v_accvgpr_read_b32 v222, a26
    v_accvgpr_read_b32 v223, a27
    v_mfma_f32_16x16x32_bf16 a[56:59], v[112:115], v[80:83], a[56:59]
    v_accvgpr_read_b32 v224, a36
    v_accvgpr_read_b32 v225, a37
    v_mfma_f32_16x16x32_bf16 a[48:51], v[136:139], v[84:87], a[48:51]
    v_accvgpr_read_b32 v226, a38
    v_accvgpr_read_b32 v227, a39
    v_mfma_f32_16x16x32_bf16 a[52:55], v[136:139], v[88:91], a[52:55]
    v_cvt_pk_bf16_f32 v228, v220, v221
    v_cvt_pk_bf16_f32 v229, v222, v223
    v_mfma_f32_16x16x32_bf16 a[56:59], v[136:139], v[92:95], a[56:59]
    v_cvt_pk_bf16_f32 v230, v224, v225
    v_cvt_pk_bf16_f32 v231, v226, v227
    v_mfma_f32_16x16x32_bf16 a[60:63], v[116:119], v[72:75], a[60:63]
    s_cmp_eq_u32 s24, s32
    s_cbranch_scc1 L_OWN3
    s_add_u32 s45, s43, 12288
    buffer_store_dwordx4 v[228:231], v20, s[16:19], s45 offen sc1
    s_branch L_OWD3
L_OWN3:
    ds_write_b128 v14, v[228:231] offset:3072
L_OWD3:
    v_accvgpr_read_b32 v208, a28
    v_mfma_f32_16x16x32_bf16 a[64:67], v[116:119], v[76:79], a[64:67]
    v_accvgpr_read_b32 v209, a29
    v_accvgpr_read_b32 v210, a30
    v_mfma_f32_16x16x32_bf16 a[68:71], v[116:119], v[80:83], a[68:71]
    v_accvgpr_read_b32 v211, a31
    v_accvgpr_read_b32 v212, a40
    v_mfma_f32_16x16x32_bf16 a[60:63], v[140:143], v[84:87], a[60:63]
    v_accvgpr_read_b32 v213, a41
    v_accvgpr_read_b32 v214, a42
    v_mfma_f32_16x16x32_bf16 a[64:67], v[140:143], v[88:91], a[64:67]
    v_accvgpr_read_b32 v215, a43
    v_cvt_pk_bf16_f32 v216, v208, v209
    v_mfma_f32_16x16x32_bf16 a[68:71], v[140:143], v[92:95], a[68:71]
    v_cvt_pk_bf16_f32 v217, v210, v211
    v_cvt_pk_bf16_f32 v218, v212, v213
    v_cvt_pk_bf16_f32 v219, v214, v215
    s_cmp_eq_u32 s24, s32
    s_cbranch_scc1 L_OWN4
    s_add_u32 s45, s43, 13312
    buffer_store_dwordx4 v[216:219], v20, s[16:19], s45 offen sc1
    s_branch L_OWD4
L_OWN4:
    ds_write_b128 v14, v[216:219] offset:4096
L_OWD4:
    v_accvgpr_read_b32 v220, a32
    v_accvgpr_read_b32 v221, a33
    v_accvgpr_read_b32 v222, a34
    v_accvgpr_read_b32 v223, a35
    v_accvgpr_read_b32 v224, a44
    v_accvgpr_read_b32 v225, a45
    v_accvgpr_read_b32 v226, a46
    v_accvgpr_read_b32 v227, a47
    v_cvt_pk_bf16_f32 v228, v220, v221
    v_cvt_pk_bf16_f32 v229, v222, v223
    v_cvt_pk_bf16_f32 v230, v224, v225
    v_cvt_pk_bf16_f32 v231, v226, v227
    s_cmp_eq_u32 s24, s32
    s_cbranch_scc1 L_OWN5
    s_add_u32 s45, s43, 14336
    buffer_store_dwordx4 v[228:231], v20, s[16:19], s45 offen sc1
    s_branch L_OWD5
L_OWN5:
    ds_write_b128 v14, v[228:231] offset:5120
L_OWD5:
    v_accvgpr_read_b32 v208, a48
    v_accvgpr_read_b32 v209, a49
    v_accvgpr_read_b32 v210, a50
    v_accvgpr_read_b32 v211, a51
    v_accvgpr_read_b32 v212, a60
    v_accvgpr_read_b32 v213, a61
    v_accvgpr_read_b32 v214, a62
    v_accvgpr_read_b32 v215, a63
    v_cvt_pk_bf16_f32 v216, v208, v209
    v_cvt_pk_bf16_f32 v217, v210, v211
    v_cvt_pk_bf16_f32 v218, v212, v213
    v_cvt_pk_bf16_f32 v219, v214, v215
    s_cmp_eq_u32 s24, s32
    s_cbranch_scc1 L_OWN6
    s_add_u32 s45, s43, 24576
    buffer_store_dwordx4 v[216:219], v20, s[16:19], s45 offen sc1
    s_branch L_OWD6
L_OWN6:
    ds_write_b128 v14, v[216:219] offset:6144
L_OWD6:
    v_accvgpr_read_b32 v220, a52
    v_accvgpr_read_b32 v221, a53
    v_accvgpr_read_b32 v222, a54
    v_accvgpr_read_b32 v223, a55
    v_accvgpr_read_b32 v224, a64
    v_accvgpr_read_b32 v225, a65
    v_accvgpr_read_b32 v226, a66
    v_accvgpr_read_b32 v227, a67
    v_cvt_pk_bf16_f32 v228, v220, v221
    v_cvt_pk_bf16_f32 v229, v222, v223
    v_cvt_pk_bf16_f32 v230, v224, v225
    v_cvt_pk_bf16_f32 v231, v226, v227
    s_cmp_eq_u32 s24, s32
    s_cbranch_scc1 L_OWN7
    s_add_u32 s45, s43, 25600
    buffer_store_dwordx4 v[228:231], v20, s[16:19], s45 offen sc1
    s_branch L_OWD7
L_OWN7:
    ds_write_b128 v14, v[228:231] offset:7168
L_OWD7:
    v_accvgpr_read_b32 v208, a56
    v_accvgpr_read_b32 v209, a57
    v_accvgpr_read_b32 v210, a58
    v_accvgpr_read_b32 v211, a59
    v_accvgpr_read_b32 v212, a68
    v_accvgpr_read_b32 v213, a69
    v_accvgpr_read_b32 v214, a70
    v_accvgpr_read_b32 v215, a71
    v_cvt_pk_bf16_f32 v216, v208, v209
    v_cvt_pk_bf16_f32 v217, v210, v211
    v_cvt_pk_bf16_f32 v218, v212, v213
    v_cvt_pk_bf16_f32 v219, v214, v215
    s_cmp_eq_u32 s24, s32
    s_cbranch_scc1 L_OWN8
    s_add_u32 s45, s43, 26624
    buffer_store_dwordx4 v[216:219], v20, s[16:19], s45 offen sc1
    s_branch L_OWD8
L_OWN8:
    ds_write_b128 v14, v[216:219] offset:8192
L_OWD8:
    v_lshrrev_b32 v22, 4, v1
    v_lshlrev_b32 v22, 4, v22
    s_mul_i32 s45, s24, 192
    s_add_u32 s45, s45, 36864
    s_mov_b32 s46, 0x00010001
    s_mov_b32 s47, 0x00010001
    s_mov_b64 exec, s[46:47]
    buffer_store_dwordx4 a[72:75], v22, s[16:19], s45 offen offset:0 sc1
    buffer_store_dwordx4 a[76:79], v22, s[16:19], s45 offen offset:64 sc1
    buffer_store_dwordx4 a[80:83], v22, s[16:19], s45 offen offset:128 sc1
    s_mov_b64 exec, -1
    s_cmp_eq_u32 s24, s32
    s_cbranch_scc1 L_W3
    s_waitcnt vmcnt(12) lgkmcnt(0)
    s_branch L_W3D
L_W3:
    s_waitcnt vmcnt(3) lgkmcnt(0)
L_W3D:
    s_barrier
    s_mul_i32 s41, s24, 6144
    s_add_u32 s41, s41, 122880
    v_add_u32 v10, s41, v4
    v_add_u32 v11, s41, v5
    ds_read_b128 v[24:27], v10 offset:0
    ds_read_b128 v[28:31], v11 offset:0
    ds_read_b128 v[32:35], v10 offset:1024
    ds_read_b128 v[36:39], v11 offset:1024
    ds_read_b128 v[40:43], v10 offset:2048
    ds_read_b128 v[44:47], v11 offset:2048
    s_mul_i32 s41, s24, 6144
    s_add_u32 s41, s41, 73728
    v_add_u32 v10, s41, v4
    v_add_u32 v11, s41, v5
    ds_read_b128 v[48:51], v10 offset:0
    ds_read_b128 v[52:55], v11 offset:0
    ds_read_b128 v[56:59], v10 offset:1024
    ds_read_b128 v[60:63], v11 offset:1024
    ds_read_b128 v[64:67], v10 offset:2048
    ds_read_b128 v[68:71], v11 offset:2048
    s_waitcnt lgkmcnt(0)
    s_barrier
    s_add_u32 s54, s39, 49152
    s_add_u32 s55, s39, 98304
    s_add_u32 s60, s39, 73728
    s_add_u32 s61, s39, 122880
    v_dot2_f32_bf16 v216, v24, v24, 0
    v_dot2_f32_bf16 v224, v48, v48, 0
    v_dot2_f32_bf16 v217, v25, v25, 0
    v_dot2_f32_bf16 v225, v49, v49, 0
    v_dot2_f32_bf16 v218, v26, v26, 0
    v_dot2_f32_bf16 v226, v50, v50, 0
    v_dot2_f32_bf16 v219, v27, v27, 0
    v_dot2_f32_bf16 v227, v51, v51, 0
    v_dot2_f32_bf16 v216, v28, v28, v216
    v_dot2_f32_bf16 v224, v52, v52, v224
    v_dot2_f32_bf16 v217, v29, v29, v217
    v_dot2_f32_bf16 v225, v53, v53, v225
    v_dot2_f32_bf16 v218, v30, v30, v218
    v_dot2_f32_bf16 v226, v54, v54, v226
    v_dot2_f32_bf16 v219, v31, v31, v219
    v_dot2_f32_bf16 v227, v55, v55, v227
    v_dot2_f32_bf16 v216, v32, v32, v216
    v_dot2_f32_bf16 v224, v56, v56, v224
    v_dot2_f32_bf16 v217, v33, v33, v217
    v_dot2_f32_bf16 v225, v57, v57, v225
    v_dot2_f32_bf16 v218, v34, v34, v218
    v_dot2_f32_bf16 v226, v58, v58, v226
    v_dot2_f32_bf16 v219, v35, v35, v219
    v_dot2_f32_bf16 v227, v59, v59, v227
    v_dot2_f32_bf16 v216, v36, v36, v216
    v_dot2_f32_bf16 v224, v60, v60, v224
    v_dot2_f32_bf16 v217, v37, v37, v217
    v_dot2_f32_bf16 v225, v61, v61, v225
    v_dot2_f32_bf16 v218, v38, v38, v218
    v_dot2_f32_bf16 v226, v62, v62, v226
    v_dot2_f32_bf16 v219, v39, v39, v219
    v_dot2_f32_bf16 v227, v63, v63, v227
    v_dot2_f32_bf16 v216, v40, v40, v216
    v_dot2_f32_bf16 v224, v64, v64, v224
    v_dot2_f32_bf16 v217, v41, v41, v217
    v_dot2_f32_bf16 v225, v65, v65, v225
    v_dot2_f32_bf16 v218, v42, v42, v218
    v_dot2_f32_bf16 v226, v66, v66, v226
    v_dot2_f32_bf16 v219, v43, v43, v219
    v_dot2_f32_bf16 v227, v67, v67, v227
    v_dot2_f32_bf16 v216, v44, v44, v216
    v_dot2_f32_bf16 v224, v68, v68, v224
    v_dot2_f32_bf16 v217, v45, v45, v217
    v_dot2_f32_bf16 v225, v69, v69, v225
    v_dot2_f32_bf16 v218, v46, v46, v218
    v_dot2_f32_bf16 v226, v70, v70, v226
    v_dot2_f32_bf16 v219, v47, v47, v219
    v_dot2_f32_bf16 v227, v71, v71, v227
    v_add_f32 v216, v216, v217
    v_add_f32 v224, v224, v225
    v_add_f32 v218, v218, v219
    v_add_f32 v226, v226, v227
    v_add_f32 v216, v216, v218
    v_add_f32 v224, v224, v226
    v_mov_b32 v220, v216
    v_mov_b32 v228, v224
    s_nop 0
    v_permlane16_swap_b32 v220, v216
    v_permlane16_swap_b32 v228, v224
    v_add_f32 v216, v216, v220
    v_add_f32 v224, v224, v228
    v_mov_b32 v220, v216
    v_mov_b32 v228, v224
    s_nop 0
    v_permlane32_swap_b32 v220, v216
    v_permlane32_swap_b32 v228, v224
    v_add_f32 v216, v216, v220
    v_add_f32 v224, v224, v228
    v_mul_f32 v216, 0x3d553b95, v216
    v_mul_f32 v224, 0x3d553b95, v224
    v_add_f32 v216, 0x4072b803, v216
    v_add_f32 v224, 0x4072b803, v224
    v_mul_f32 v72, 0xc02521be, v216
    v_mul_f32 v76, 0xc02521be, v224
    v_mov_b32 v73, v72
    v_mov_b32 v77, v76
    v_mov_b32 v74, v72
    v_mov_b32 v78, v76
    v_mov_b32 v75, v72
    v_mov_b32 v79, v76
    v_add_u32 v12, 49152, v4
    v_add_u32 v13, 49152, v5
    s_lshl_b32 s41, s25, 3
    s_lshl_b32 s42, s33, 2
    s_add_u32 s41, s41, s42
    s_mul_i32 s41, s41, 37888
    s_add_u32 s12, s30, s41
    s_addc_u32 s13, s31, 0
    s_mov_b32 s14, 151552
    s_mov_b32 s15, 0x00020000
    s_mul_i32 s41, s25, 73728
    s_add_u32 s16, s30, s41
    s_addc_u32 s17, s31, 0
    s_add_u32 s16, s16, 33554432
    s_addc_u32 s17, s17, 0
    s_mov_b32 s18, 73728
    s_mov_b32 s19, 0x00020000
    s_lshl_b32 s41, s24, 11
    s_add_u32 s41, s41, 147456
    v_add_u32 v14, s41, v20
    s_lshl_b32 s41, s24, 8
    s_add_u32 s41, s41, 155648
    v_add_u32 v15, s41, v20
    s_add_u32 s41, s32, 1
    s_and_b32 s41, s41, 3
    s_mul_i32 s50, s41, 37888
    s_add_u32 s41, s32, 2
    s_and_b32 s41, s41, 3
    s_mul_i32 s51, s41, 37888
    s_add_u32 s41, s32, 3
    s_and_b32 s41, s41, 3
    s_mul_i32 s52, s41, 37888
    s_waitcnt vmcnt(0)
    s_barrier
    s_cmp_lg_u32 s24, 0
    s_cbranch_scc1 L_SIG1
    v_readfirstlane_b32 s46, v252
    s_nop 3
    s_cmp_lg_u32 s46, 0
    s_cbranch_scc1 L_SIG1_J
    s_mov_b32 s45, 100000
L_SIG1_I:
    global_load_dword v23, v253, s[28:29] offset:128 sc1
    s_waitcnt vmcnt(0)
    v_readfirstlane_b32 s46, v23
    s_sub_u32 s45, s45, 1
    s_cmp_eq_u32 s45, 0
    s_cbranch_scc1 L_SIG1_J
    s_nop 0
    s_cmp_eq_u32 s46, 0
    s_cbranch_scc1 L_SIG1_I
L_SIG1_J:
    v_mov_b32 v22, s62
    v_mov_b32 v23, 1
    s_mov_b64 exec, 1
    global_atomic_add v22, v23, s[64:65] sc1
    s_mov_b64 exec, -1
L_SIG1:
    s_cmp_eq_u32 s24, 0
    s_cbranch_scc1 L_NOQ23
    s_lshl_b32 s41, s35, 6
    v_xor_b32 v16, s41, v2
    v_xor_b32 v17, 64, v16
    s_sub_u32 s41, s24, 1
    s_lshl_b32 s42, s41, 7
    s_lshl_b32 s43, s41, 10
    s_add_u32 m0, s43, 98304
    s_add_u32 s45, s42, 49152
    buffer_load_dwordx4 v16, s[8:11], s45 offen nt lds
    s_add_u32 m0, s43, 101376
    s_add_u32 s45, s42, 52224
    buffer_load_dwordx4 v17, s[8:11], s45 offen nt lds
    s_add_u32 m0, s43, 104448
    s_add_u32 s45, s42, 55296
    buffer_load_dwordx4 v16, s[8:11], s45 offen nt lds
    s_add_u32 m0, s43, 107520
    s_add_u32 s45, s42, 58368
    buffer_load_dwordx4 v17, s[8:11], s45 offen nt lds
    s_add_u32 m0, s43, 110592
    s_add_u32 s45, s42, 61440
    buffer_load_dwordx4 v16, s[8:11], s45 offen nt lds
    s_add_u32 m0, s43, 113664
    s_add_u32 s45, s42, 64512
    buffer_load_dwordx4 v17, s[8:11], s45 offen nt lds
    s_add_u32 m0, s43, 116736
    s_add_u32 s45, s42, 67584
    buffer_load_dwordx4 v16, s[8:11], s45 offen nt lds
    s_add_u32 m0, s43, 119808
    s_add_u32 s45, s42, 70656
    buffer_load_dwordx4 v17, s[8:11], s45 offen nt lds
L_NOQ23:
    ds_read_b128 a[0:3], v4 offset:0
    ds_read_b128 a[4:7], v5 offset:0
    ds_read_b128 a[8:11], v4 offset:1024
    ds_read_b128 a[12:15], v5 offset:1024
    ds_read_b128 a[16:19], v4 offset:2048
    ds_read_b128 a[20:23], v5 offset:2048
    s_waitcnt lgkmcnt(4)
    v_mfma_f32_16x16x32_bf16 v[216:219], a[0:3], v[24:27], v[72:75]
    ds_read_b128 a[24:27], v4 offset:6144
    ds_read_b128 a[28:31], v5 offset:6144
    v_mfma_f32_16x16x32_bf16 v[220:223], a[0:3], v[48:51], v[76:79]
    ds_read_b128 a[32:35], v4 offset:7168
    ds_read_b128 a[36:39], v5 offset:7168
    v_mfma_f32_16x16x32_bf16 v[216:219], a[4:7], v[28:31], v[216:219]
    ds_read_b128 a[40:43], v4 offset:8192
    ds_read_b128 a[44:47], v5 offset:8192
    v_mfma_f32_16x16x32_bf16 v[220:223], a[4:7], v[52:55], v[220:223]
    s_waitcnt lgkmcnt(8)
    v_mfma_f32_16x16x32_bf16 v[216:219], a[8:11], v[32:35], v[216:219]
    v_mfma_f32_16x16x32_bf16 v[220:223], a[8:11], v[56:59], v[220:223]
    v_mfma_f32_16x16x32_bf16 v[216:219], a[12:15], v[36:39], v[216:219]
    v_mfma_f32_16x16x32_bf16 v[220:223], a[12:15], v[60:63], v[220:223]
    s_waitcnt lgkmcnt(6)
    v_mfma_f32_16x16x32_bf16 v[216:219], a[16:19], v[40:43], v[216:219]
    v_mfma_f32_16x16x32_bf16 v[220:223], a[16:19], v[64:67], v[220:223]
    v_mfma_f32_16x16x32_bf16 v[216:219], a[20:23], v[44:47], v[216:219]
    v_mfma_f32_16x16x32_bf16 v[220:223], a[20:23], v[68:71], v[220:223]
    s_waitcnt lgkmcnt(4)
    v_mfma_f32_16x16x32_bf16 v[224:227], a[24:27], v[24:27], v[72:75]
    ds_read_b128 a[0:3], v4 offset:12288
    s_nop 3
    v_mul_f32 v216, s40, v216
    v_mfma_f32_16x16x32_bf16 v[228:231], a[24:27], v[48:51], v[76:79]
    ds_read_b128 a[4:7], v5 offset:12288
    v_mul_f32 v217, s40, v217
    v_mfma_f32_16x16x32_bf16 v[224:227], a[28:31], v[28:31], v[224:227]
    ds_read_b128 a[8:11], v4 offset:13312
    v_mul_f32 v218, s40, v218
    v_mfma_f32_16x16x32_bf16 v[228:231], a[28:31], v[52:55], v[228:231]
    ds_read_b128 a[12:15], v5 offset:13312
    s_waitcnt lgkmcnt(6)
    v_mul_f32 v219, s40, v219
    v_mfma_f32_16x16x32_bf16 v[224:227], a[32:35], v[32:35], v[224:227]
    ds_read_b128 a[16:19], v4 offset:14336
    v_mul_f32 v220, s40, v220
    v_mfma_f32_16x16x32_bf16 v[228:231], a[32:35], v[56:59], v[228:231]
    ds_read_b128 a[20:23], v5 offset:14336
    v_mul_f32 v221, s40, v221
    v_mfma_f32_16x16x32_bf16 v[224:227], a[36:39], v[36:39], v[224:227]
    v_mul_f32 v222, s40, v222
    v_mul_f32 v223, s40, v223
    v_mfma_f32_16x16x32_bf16 v[228:231], a[36:39], v[60:63], v[228:231]
    s_waitcnt lgkmcnt(6)
    v_exp_f32 v216, v216
    v_mfma_f32_16x16x32_bf16 v[224:227], a[40:43], v[40:43], v[224:227]
    v_exp_f32 v217, v217
    v_mfma_f32_16x16x32_bf16 v[228:231], a[40:43], v[64:67], v[228:231]
    v_exp_f32 v218, v218
    v_mfma_f32_16x16x32_bf16 v[224:227], a[44:47], v[44:47], v[224:227]
    v_exp_f32 v219, v219
    v_mfma_f32_16x16x32_bf16 v[228:231], a[44:47], v[68:71], v[228:231]
    v_exp_f32 v220, v220
    v_exp_f32 v221, v221
    v_exp_f32 v222, v222
    v_exp_f32 v223, v223
    v_cvt_pk_bf16_f32 v120, v216, v217
    v_cvt_pk_bf16_f32 v121, v218, v219
    v_cvt_pk_bf16_f32 v124, v220, v221
    v_cvt_pk_bf16_f32 v125, v222, v223
    s_waitcnt lgkmcnt(4)
    v_mfma_f32_16x16x32_bf16 v[216:219], a[0:3], v[24:27], v[72:75]
    ds_read_b128 a[24:27], v4 offset:18432
    v_mul_f32 v224, s40, v224
    v_mfma_f32_16x16x32_bf16 v[220:223], a[0:3], v[48:51], v[76:79]
    ds_read_b128 a[28:31], v5 offset:18432
    v_mul_f32 v225, s40, v225
    v_mfma_f32_16x16x32_bf16 v[216:219], a[4:7], v[28:31], v[216:219]
    ds_read_b128 a[32:35], v4 offset:19456
    v_mul_f32 v226, s40, v226
    v_mfma_f32_16x16x32_bf16 v[220:223], a[4:7], v[52:55], v[220:223]
    ds_read_b128 a[36:39], v5 offset:19456
    s_waitcnt lgkmcnt(6)
    v_mul_f32 v227, s40, v227
    v_mfma_f32_16x16x32_bf16 v[216:219], a[8:11], v[32:35], v[216:219]
    ds_read_b128 a[40:43], v4 offset:20480
    v_mul_f32 v228, s40, v228
    v_mfma_f32_16x16x32_bf16 v[220:223], a[8:11], v[56:59], v[220:223]
    ds_read_b128 a[44:47], v5 offset:20480
    v_mul_f32 v229, s40, v229
    v_mfma_f32_16x16x32_bf16 v[216:219], a[12:15], v[36:39], v[216:219]
    v_mul_f32 v230, s40, v230
    v_mul_f32 v231, s40, v231
    v_mfma_f32_16x16x32_bf16 v[220:223], a[12:15], v[60:63], v[220:223]
    s_waitcnt lgkmcnt(6)
    v_exp_f32 v224, v224
    v_mfma_f32_16x16x32_bf16 v[216:219], a[16:19], v[40:43], v[216:219]
    v_exp_f32 v225, v225
    v_mfma_f32_16x16x32_bf16 v[220:223], a[16:19], v[64:67], v[220:223]
    v_exp_f32 v226, v226
    v_mfma_f32_16x16x32_bf16 v[216:219], a[20:23], v[44:47], v[216:219]
    v_exp_f32 v227, v227
    v_mfma_f32_16x16x32_bf16 v[220:223], a[20:23], v[68:71], v[220:223]
    v_exp_f32 v228, v228
    v_exp_f32 v229, v229
    v_exp_f32 v230, v230
    v_exp_f32 v231, v231
    v_cvt_pk_bf16_f32 v122, v224, v225
    v_cvt_pk_bf16_f32 v123, v226, v227
    v_cvt_pk_bf16_f32 v126, v228, v229
    v_cvt_pk_bf16_f32 v127, v230, v231
    s_waitcnt lgkmcnt(4)
    v_mfma_f32_16x16x32_bf16 v[224:227], a[24:27], v[24:27], v[72:75]
    ds_read_b128 a[0:3], v4 offset:24576
    v_mul_f32 v216, s40, v216
    v_mfma_f32_16x16x32_bf16 v[228:231], a[24:27], v[48:51], v[76:79]
    ds_read_b128 a[4:7], v5 offset:24576
    v_mul_f32 v217, s40, v217
    v_mfma_f32_16x16x32_bf16 v[224:227], a[28:31], v[28:31], v[224:227]
    ds_read_b128 a[8:11], v4 offset:25600
    v_mul_f32 v218, s40, v218
    v_mfma_f32_16x16x32_bf16 v[228:231], a[28:31], v[52:55], v[228:231]
    ds_read_b128 a[12:15], v5 offset:25600
    s_waitcnt lgkmcnt(6)
    v_mul_f32 v219, s40, v219
    v_mfma_f32_16x16x32_bf16 v[224:227], a[32:35], v[32:35], v[224:227]
    ds_read_b128 a[16:19], v4 offset:26624
    v_mul_f32 v220, s40, v220
    v_mfma_f32_16x16x32_bf16 v[228:231], a[32:35], v[56:59], v[228:231]
    ds_read_b128 a[20:23], v5 offset:26624
    v_mul_f32 v221, s40, v221
    v_mfma_f32_16x16x32_bf16 v[224:227], a[36:39], v[36:39], v[224:227]
    v_mul_f32 v222, s40, v222
    v_mul_f32 v223, s40, v223
    v_mfma_f32_16x16x32_bf16 v[228:231], a[36:39], v[60:63], v[228:231]
    s_waitcnt lgkmcnt(6)
    v_exp_f32 v216, v216
    v_mfma_f32_16x16x32_bf16 v[224:227], a[40:43], v[40:43], v[224:227]
    v_exp_f32 v217, v217
    v_mfma_f32_16x16x32_bf16 v[228:231], a[40:43], v[64:67], v[228:231]
    v_exp_f32 v218, v218
    v_mfma_f32_16x16x32_bf16 v[224:227], a[44:47], v[44:47], v[224:227]
    v_exp_f32 v219, v219
    v_mfma_f32_16x16x32_bf16 v[228:231], a[44:47], v[68:71], v[228:231]
    v_exp_f32 v220, v220
    v_exp_f32 v221, v221
    v_exp_f32 v222, v222
    v_exp_f32 v223, v223
    v_cvt_pk_bf16_f32 v136, v216, v217
    v_cvt_pk_bf16_f32 v137, v218, v219
    v_cvt_pk_bf16_f32 v140, v220, v221
    v_cvt_pk_bf16_f32 v141, v222, v223
    s_waitcnt lgkmcnt(4)
    v_mfma_f32_16x16x32_bf16 v[216:219], a[0:3], v[24:27], v[72:75]
    ds_read_b128 a[24:27], v4 offset:30720
    v_mul_f32 v224, s40, v224
    v_mfma_f32_16x16x32_bf16 v[220:223], a[0:3], v[48:51], v[76:79]
    ds_read_b128 a[28:31], v5 offset:30720
    v_mul_f32 v225, s40, v225
    v_mfma_f32_16x16x32_bf16 v[216:219], a[4:7], v[28:31], v[216:219]
    ds_read_b128 a[32:35], v4 offset:31744
    v_mul_f32 v226, s40, v226
    v_mfma_f32_16x16x32_bf16 v[220:223], a[4:7], v[52:55], v[220:223]
    ds_read_b128 a[36:39], v5 offset:31744
    s_waitcnt lgkmcnt(6)
    v_mul_f32 v227, s40, v227
    v_mfma_f32_16x16x32_bf16 v[216:219], a[8:11], v[32:35], v[216:219]
    ds_read_b128 a[40:43], v4 offset:32768
    v_mul_f32 v228, s40, v228
    v_mfma_f32_16x16x32_bf16 v[220:223], a[8:11], v[56:59], v[220:223]
    ds_read_b128 a[44:47], v5 offset:32768
    v_mul_f32 v229, s40, v229
    v_mfma_f32_16x16x32_bf16 v[216:219], a[12:15], v[36:39], v[216:219]
    v_mul_f32 v230, s40, v230
    v_mul_f32 v231, s40, v231
    v_mfma_f32_16x16x32_bf16 v[220:223], a[12:15], v[60:63], v[220:223]
    s_waitcnt lgkmcnt(6)
    v_exp_f32 v224, v224
    v_mfma_f32_16x16x32_bf16 v[216:219], a[16:19], v[40:43], v[216:219]
    v_exp_f32 v225, v225
    v_mfma_f32_16x16x32_bf16 v[220:223], a[16:19], v[64:67], v[220:223]
    v_exp_f32 v226, v226
    v_mfma_f32_16x16x32_bf16 v[216:219], a[20:23], v[44:47], v[216:219]
    v_exp_f32 v227, v227
    v_mfma_f32_16x16x32_bf16 v[220:223], a[20:23], v[68:71], v[220:223]
    v_exp_f32 v228, v228
    v_exp_f32 v229, v229
    v_exp_f32 v230, v230
    v_exp_f32 v231, v231
    v_cvt_pk_bf16_f32 v138, v224, v225
    v_cvt_pk_bf16_f32 v139, v226, v227
    v_cvt_pk_bf16_f32 v142, v228, v229
    v_cvt_pk_bf16_f32 v143, v230, v231
    s_waitcnt lgkmcnt(4)
    v_mfma_f32_16x16x32_bf16 v[224:227], a[24:27], v[24:27], v[72:75]
    ds_read_b128 a[0:3], v4 offset:36864
    v_mul_f32 v216, s40, v216
    v_mfma_f32_16x16x32_bf16 v[228:231], a[24:27], v[48:51], v[76:79]
    ds_read_b128 a[4:7], v5 offset:36864
    v_mul_f32 v217, s40, v217
    v_mfma_f32_16x16x32_bf16 v[224:227], a[28:31], v[28:31], v[224:227]
    ds_read_b128 a[8:11], v4 offset:37888
    v_mul_f32 v218, s40, v218
    v_mfma_f32_16x16x32_bf16 v[228:231], a[28:31], v[52:55], v[228:231]
    ds_read_b128 a[12:15], v5 offset:37888
    s_waitcnt lgkmcnt(6)
    v_mul_f32 v219, s40, v219
    v_mfma_f32_16x16x32_bf16 v[224:227], a[32:35], v[32:35], v[224:227]
    ds_read_b128 a[16:19], v4 offset:38912
    v_mul_f32 v220, s40, v220
    v_mfma_f32_16x16x32_bf16 v[228:231], a[32:35], v[56:59], v[228:231]
    ds_read_b128 a[20:23], v5 offset:38912
    v_mul_f32 v221, s40, v221
    v_mfma_f32_16x16x32_bf16 v[224:227], a[36:39], v[36:39], v[224:227]
    v_mul_f32 v222, s40, v222
    v_mul_f32 v223, s40, v223
    v_mfma_f32_16x16x32_bf16 v[228:231], a[36:39], v[60:63], v[228:231]
    s_waitcnt lgkmcnt(6)
    v_exp_f32 v216, v216
    v_mfma_f32_16x16x32_bf16 v[224:227], a[40:43], v[40:43], v[224:227]
    v_exp_f32 v217, v217
    v_mfma_f32_16x16x32_bf16 v[228:231], a[40:43], v[64:67], v[228:231]
    v_exp_f32 v218, v218
    v_mfma_f32_16x16x32_bf16 v[224:227], a[44:47], v[44:47], v[224:227]
    v_exp_f32 v219, v219
    v_mfma_f32_16x16x32_bf16 v[228:231], a[44:47], v[68:71], v[228:231]
    v_exp_f32 v220, v220
    v_exp_f32 v221, v221
    v_exp_f32 v222, v222
    v_exp_f32 v223, v223
    v_cvt_pk_bf16_f32 v152, v216, v217
    v_cvt_pk_bf16_f32 v153, v218, v219
    v_cvt_pk_bf16_f32 v156, v220, v221
    v_cvt_pk_bf16_f32 v157, v222, v223
    s_waitcnt lgkmcnt(4)
    v_mfma_f32_16x16x32_bf16 v[216:219], a[0:3], v[24:27], v[72:75]
    v_mul_f32 v224, s40, v224
    v_mul_f32 v225, s40, v225
    v_mfma_f32_16x16x32_bf16 v[220:223], a[0:3], v[48:51], v[76:79]
    v_mul_f32 v226, s40, v226
    v_mul_f32 v227, s40, v227
    v_mfma_f32_16x16x32_bf16 v[216:219], a[4:7], v[28:31], v[216:219]
    v_mul_f32 v228, s40, v228
    v_mul_f32 v229, s40, v229
    v_mfma_f32_16x16x32_bf16 v[220:223], a[4:7], v[52:55], v[220:223]
    s_waitcnt lgkmcnt(2)
    v_mul_f32 v230, s40, v230
    v_mul_f32 v231, s40, v231
    v_mfma_f32_16x16x32_bf16 v[216:219], a[8:11], v[32:35], v[216:219]
    v_exp_f32 v224, v224
    v_mfma_f32_16x16x32_bf16 v[220:223], a[8:11], v[56:59], v[220:223]
    v_exp_f32 v225, v225
    v_mfma_f32_16x16x32_bf16 v[216:219], a[12:15], v[36:39], v[216:219]
    v_exp_f32 v226, v226
    v_mfma_f32_16x16x32_bf16 v[220:223], a[12:15], v[60:63], v[220:223]
    s_waitcnt lgkmcnt(0)
    v_exp_f32 v227, v227
    v_mfma_f32_16x16x32_bf16 v[216:219], a[16:19], v[40:43], v[216:219]
    v_exp_f32 v228, v228
    v_mfma_f32_16x16x32_bf16 v[220:223], a[16:19], v[64:67], v[220:223]
    v_exp_f32 v229, v229
    v_mfma_f32_16x16x32_bf16 v[216:219], a[20:23], v[44:47], v[216:219]
    v_exp_f32 v230, v230
    v_mfma_f32_16x16x32_bf16 v[220:223], a[20:23], v[68:71], v[220:223]
    v_exp_f32 v231, v231
    v_cvt_pk_bf16_f32 v154, v224, v225
    v_cvt_pk_bf16_f32 v155, v226, v227
    v_cvt_pk_bf16_f32 v158, v228, v229
    v_cvt_pk_bf16_f32 v159, v230, v231
    s_nop 0
    v_mul_f32 v216, s40, v216
    v_mul_f32 v217, s40, v217
    v_mul_f32 v218, s40, v218
    v_mul_f32 v219, s40, v219
    v_mul_f32 v220, s40, v220
    v_mul_f32 v221, s40, v221
    v_mul_f32 v222, s40, v222
    v_mul_f32 v223, s40, v223
    v_exp_f32 v216, v216
    v_exp_f32 v217, v217
    v_exp_f32 v218, v218
    v_exp_f32 v219, v219
    v_exp_f32 v220, v220
    v_exp_f32 v221, v221
    v_exp_f32 v222, v222
    v_exp_f32 v223, v223
    v_cvt_pk_bf16_f32 v168, v216, v217
    v_cvt_pk_bf16_f32 v169, v218, v219
    v_cvt_pk_bf16_f32 v172, v220, v221
    v_cvt_pk_bf16_f32 v173, v222, v223
    s_cmp_lg_u32 s24, 0
    s_cbranch_scc1 L_POLL1_DONE
    v_mov_b32 v22, 0
    s_mov_b32 s45, 100000
L_POLL1:
    global_load_dword v23, v22, s[64:65] sc1
    global_load_dword v255, v22, s[64:65] offset:128 sc1
    s_waitcnt vmcnt(0)
    v_readfirstlane_b32 s46, v23
    v_readfirstlane_b32 s47, v255
    s_nop 3
    s_min_u32 s46, s46, s47
    s_sub_u32 s45, s45, 1
    s_cmp_eq_u32 s45, 0
    s_cbranch_scc1 L_POLL1_DONE
    s_cmp_ge_u32 s46, 4
    s_cbranch_scc1 L_POLL1_DONE
    s_sleep 1
    s_branch L_POLL1
L_POLL1_DONE:
    s_barrier
    s_add_u32 s41, s66, s50
    buffer_load_dwordx4 a[48:51], v20, s[12:15], s41 offen sc1
    s_add_u32 s41, s66, s51
    buffer_load_dwordx4 a[52:55], v20, s[12:15], s41 offen sc1
    s_add_u32 s41, s66, s52
    buffer_load_dwordx4 a[56:59], v20, s[12:15], s41 offen sc1
    s_add_u32 s41, s67, s50
    buffer_load_dwordx4 a[60:63], v20, s[12:15], s41 offen sc1
    s_add_u32 s41, s67, s51
    buffer_load_dwordx4 a[64:67], v20, s[12:15], s41 offen sc1
    s_add_u32 s41, s67, s52
    buffer_load_dwordx4 a[68:71], v20, s[12:15], s41 offen sc1
    s_mov_b64 exec, 0xffff
    s_add_u32 s41, s68, s50
    buffer_load_dwordx4 a[72:75], v20, s[12:15], s41 offen sc1
    s_add_u32 s41, s68, s51
    buffer_load_dwordx4 a[76:79], v20, s[12:15], s41 offen sc1
    s_add_u32 s41, s68, s52
    buffer_load_dwordx4 a[80:83], v20, s[12:15], s41 offen sc1
    s_mov_b64 exec, -1
    ds_read_b128 a[24:27], v4 offset:43008
    ds_read_b128 a[28:31], v5 offset:43008
    ds_read_b128 a[32:35], v4 offset:44032
    ds_read_b128 a[36:39], v5 offset:44032
    ds_read_b128 a[40:43], v4 offset:45056
    ds_read_b128 a[44:47], v5 offset:45056
    s_waitcnt lgkmcnt(4)
    v_mfma_f32_16x16x32_bf16 v[224:227], a[24:27], v[24:27], v[72:75]
    ds_read_b128 a[0:3], v12 offset:0
    s_mov_b32 m0, s61
    v_mfma_f32_16x16x32_bf16 v[228:231], a[24:27], v[48:51], v[76:79]
    ds_read_b128 a[4:7], v13 offset:0
    buffer_load_dwordx4 v2, s[8:11], s60 offen offset:0 nt lds
    v_mfma_f32_16x16x32_bf16 v[224:227], a[28:31], v[28:31], v[224:227]
    ds_read_b128 a[8:11], v12 offset:1024
    s_add_u32 m0, m0, 896
    v_mfma_f32_16x16x32_bf16 v[228:231], a[28:31], v[52:55], v[228:231]
    ds_read_b128 a[12:15], v13 offset:1024
    ds_read_b128 a[16:19], v12 offset:2048
    s_waitcnt lgkmcnt(7)
    v_mfma_f32_16x16x32_bf16 v[224:227], a[32:35], v[32:35], v[224:227]
    ds_read_b128 a[20:23], v13 offset:2048
    v_mfma_f32_16x16x32_bf16 v[228:231], a[32:35], v[56:59], v[228:231]
    v_mfma_f32_16x16x32_bf16 v[224:227], a[36:39], v[36:39], v[224:227]
    v_mfma_f32_16x16x32_bf16 v[228:231], a[36:39], v[60:63], v[228:231]
    s_waitcnt lgkmcnt(6)
    v_mfma_f32_16x16x32_bf16 v[224:227], a[40:43], v[40:43], v[224:227]
    v_mfma_f32_16x16x32_bf16 v[228:231], a[40:43], v[64:67], v[228:231]
    v_mfma_f32_16x16x32_bf16 v[224:227], a[44:47], v[44:47], v[224:227]
    v_mfma_f32_16x16x32_bf16 v[228:231], a[44:47], v[68:71], v[228:231]
    s_waitcnt lgkmcnt(4)
    v_mfma_f32_16x16x32_bf16 v[216:219], a[0:3], v[24:27], v[72:75]
    ds_read_b128 a[24:27], v12 offset:6144
    s_nop 3
    v_mul_f32 v224, s40, v224
    v_mfma_f32_16x16x32_bf16 v[220:223], a[0:3], v[48:51], v[76:79]
    buffer_load_dwordx4 v2, s[8:11], s60 offen offset:128 nt lds
    v_mul_f32 v225, s40, v225
    v_mfma_f32_16x16x32_bf16 v[216:219], a[4:7], v[28:31], v[216:219]
    ds_read_b128 a[28:31], v13 offset:6144
    v_mul_f32 v226, s40, v226
    v_mfma_f32_16x16x32_bf16 v[220:223], a[4:7], v[52:55], v[220:223]
    s_waitcnt lgkmcnt(4)
    v_mul_f32 v227, s40, v227
    v_mul_f32 v228, s40, v228
    v_mfma_f32_16x16x32_bf16 v[216:219], a[8:11], v[32:35], v[216:219]
    s_add_u32 m0, m0, 896
    ds_read_b128 a[32:35], v12 offset:7168
    v_mul_f32 v229, s40, v229
    v_mfma_f32_16x16x32_bf16 v[220:223], a[8:11], v[56:59], v[220:223]
    buffer_load_dwordx4 v2, s[8:11], s60 offen offset:256 nt lds
    v_mul_f32 v230, s40, v230
    v_mfma_f32_16x16x32_bf16 v[216:219], a[12:15], v[36:39], v[216:219]
    ds_read_b128 a[36:39], v13 offset:7168
    v_mul_f32 v231, s40, v231
    v_mfma_f32_16x16x32_bf16 v[220:223], a[12:15], v[60:63], v[220:223]
    s_waitcnt lgkmcnt(4)
    v_exp_f32 v224, v224
    v_mfma_f32_16x16x32_bf16 v[216:219], a[16:19], v[40:43], v[216:219]
    v_exp_f32 v225, v225
    v_mfma_f32_16x16x32_bf16 v[220:223], a[16:19], v[64:67], v[220:223]
    v_exp_f32 v226, v226
    v_mfma_f32_16x16x32_bf16 v[216:219], a[20:23], v[44:47], v[216:219]
    ds_read_b128 a[40:43], v12 offset:8192
    v_mfma_f32_16x16x32_bf16 v[220:223], a[20:23], v[68:71], v[220:223]
    ds_read_b128 a[44:47], v13 offset:8192
    v_exp_f32 v227, v227
    v_exp_f32 v228, v228
    v_exp_f32 v229, v229
    v_exp_f32 v230, v230
    v_exp_f32 v231, v231
    v_cvt_pk_bf16_f32 v170, v224, v225
    v_cvt_pk_bf16_f32 v171, v226, v227
    v_cvt_pk_bf16_f32 v174, v228, v229
    v_cvt_pk_bf16_f32 v175, v230, v231
    s_waitcnt lgkmcnt(4)
    v_mfma_f32_16x16x32_bf16 v[224:227], a[24:27], v[24:27], v[72:75]
    ds_read_b128 a[0:3], v12 offset:12288
    v_mul_f32 v216, s40, v216
    v_mfma_f32_16x16x32_bf16 v[228:231], a[24:27], v[48:51], v[76:79]
    s_add_u32 s45, s60, 12288
    ds_read_b128 a[4:7], v13 offset:12288
    v_mul_f32 v217, s40, v217
    v_mfma_f32_16x16x32_bf16 v[224:227], a[28:31], v[28:31], v[224:227]
    s_add_u32 m0, s61, 12288
    ds_read_b128 a[8:11], v12 offset:13312
    v_mul_f32 v218, s40, v218
    v_mfma_f32_16x16x32_bf16 v[228:231], a[28:31], v[52:55], v[228:231]
    buffer_load_dwordx4 v2, s[8:11], s45 offen offset:0 nt lds
    s_waitcnt lgkmcnt(5)
    v_mul_f32 v219, s40, v219
    v_mfma_f32_16x16x32_bf16 v[224:227], a[32:35], v[32:35], v[224:227]
    ds_read_b128 a[12:15], v13 offset:13312
    v_mul_f32 v220, s40, v220
    v_mfma_f32_16x16x32_bf16 v[228:231], a[32:35], v[56:59], v[228:231]
    ds_read_b128 a[16:19], v12 offset:14336
    v_mul_f32 v221, s40, v221
    v_mfma_f32_16x16x32_bf16 v[224:227], a[36:39], v[36:39], v[224:227]
    ds_read_b128 a[20:23], v13 offset:14336
    v_mul_f32 v222, s40, v222
    v_mfma_f32_16x16x32_bf16 v[228:231], a[36:39], v[60:63], v[228:231]
    s_waitcnt lgkmcnt(6)
    v_mul_f32 v223, s40, v223
    v_mfma_f32_16x16x32_bf16 v[224:227], a[40:43], v[40:43], v[224:227]
    v_exp_f32 v216, v216
    v_mfma_f32_16x16x32_bf16 v[228:231], a[40:43], v[64:67], v[228:231]
    v_exp_f32 v217, v217
    v_mfma_f32_16x16x32_bf16 v[224:227], a[44:47], v[44:47], v[224:227]
    v_exp_f32 v218, v218
    v_mfma_f32_16x16x32_bf16 v[228:231], a[44:47], v[68:71], v[228:231]
    v_exp_f32 v219, v219
    v_exp_f32 v220, v220
    v_exp_f32 v221, v221
    v_exp_f32 v222, v222
    v_exp_f32 v223, v223
    v_cvt_pk_bf16_f32 v184, v216, v217
    v_cvt_pk_bf16_f32 v185, v218, v219
    v_cvt_pk_bf16_f32 v188, v220, v221
    v_cvt_pk_bf16_f32 v189, v222, v223
    s_waitcnt lgkmcnt(4)
    v_mfma_f32_16x16x32_bf16 v[216:219], a[0:3], v[24:27], v[72:75]
    ds_read_b128 a[24:27], v12 offset:18432
    v_mul_f32 v224, s40, v224
    v_mfma_f32_16x16x32_bf16 v[220:223], a[0:3], v[48:51], v[76:79]
    s_add_u32 m0, m0, 896
    ds_read_b128 a[28:31], v13 offset:18432
    v_mul_f32 v225, s40, v225
    v_mfma_f32_16x16x32_bf16 v[216:219], a[4:7], v[28:31], v[216:219]
    buffer_load_dwordx4 v2, s[8:11], s45 offen offset:128 nt lds
    v_mul_f32 v226, s40, v226
    v_mfma_f32_16x16x32_bf16 v[220:223], a[4:7], v[52:55], v[220:223]
    ds_read_b128 a[32:35], v12 offset:19456
    s_waitcnt lgkmcnt(5)
    v_mul_f32 v227, s40, v227
    v_mfma_f32_16x16x32_bf16 v[216:219], a[8:11], v[32:35], v[216:219]
    s_add_u32 m0, m0, 896
    ds_read_b128 a[36:39], v13 offset:19456
    v_mul_f32 v228, s40, v228
    v_mfma_f32_16x16x32_bf16 v[220:223], a[8:11], v[56:59], v[220:223]
    ds_read_b128 a[40:43], v12 offset:20480
    v_mul_f32 v229, s40, v229
    v_mfma_f32_16x16x32_bf16 v[216:219], a[12:15], v[36:39], v[216:219]
    ds_read_b128 a[44:47], v13 offset:20480
    v_mul_f32 v230, s40, v230
    v_mfma_f32_16x16x32_bf16 v[220:223], a[12:15], v[60:63], v[220:223]
    s_waitcnt lgkmcnt(6)
    v_mul_f32 v231, s40, v231
    v_mfma_f32_16x16x32_bf16 v[216:219], a[16:19], v[40:43], v[216:219]
    v_exp_f32 v224, v224
    v_mfma_f32_16x16x32_bf16 v[220:223], a[16:19], v[64:67], v[220:223]
    v_exp_f32 v225, v225
    v_mfma_f32_16x16x32_bf16 v[216:219], a[20:23], v[44:47], v[216:219]
    v_exp_f32 v226, v226
    v_mfma_f32_16x16x32_bf16 v[220:223], a[20:23], v[68:71], v[220:223]
    v_exp_f32 v227, v227
    v_exp_f32 v228, v228
    v_exp_f32 v229, v229
    v_exp_f32 v230, v230
    v_exp_f32 v231, v231
    v_cvt_pk_bf16_f32 v186, v224, v225
    v_cvt_pk_bf16_f32 v187, v226, v227
    v_cvt_pk_bf16_f32 v190, v228, v229
    v_cvt_pk_bf16_f32 v191, v230, v231
    s_waitcnt lgkmcnt(4)
    v_mfma_f32_16x16x32_bf16 v[224:227], a[24:27], v[24:27], v[72:75]
    buffer_load_dwordx4 v2, s[8:11], s45 offen offset:256 nt lds
    v_mul_f32 v216, s40, v216
    v_mfma_f32_16x16x32_bf16 v[228:231], a[24:27], v[48:51], v[76:79]
    v_mul_f32 v217, s40, v217
    v_mul_f32 v218, s40, v218
    v_mfma_f32_16x16x32_bf16 v[224:227], a[28:31], v[28:31], v[224:227]
    v_mul_f32 v219, s40, v219
    v_mul_f32 v220, s40, v220
    v_mfma_f32_16x16x32_bf16 v[228:231], a[28:31], v[52:55], v[228:231]
    s_waitcnt lgkmcnt(2)
    v_mul_f32 v221, s40, v221
    v_mul_f32 v222, s40, v222
    v_mfma_f32_16x16x32_bf16 v[224:227], a[32:35], v[32:35], v[224:227]
    v_mul_f32 v223, s40, v223
    v_mfma_f32_16x16x32_bf16 v[228:231], a[32:35], v[56:59], v[228:231]
    v_exp_f32 v216, v216
    v_mfma_f32_16x16x32_bf16 v[224:227], a[36:39], v[36:39], v[224:227]
    v_exp_f32 v217, v217
    v_mfma_f32_16x16x32_bf16 v[228:231], a[36:39], v[60:63], v[228:231]
    s_waitcnt lgkmcnt(0)
    v_exp_f32 v218, v218
    v_mfma_f32_16x16x32_bf16 v[224:227], a[40:43], v[40:43], v[224:227]
    v_exp_f32 v219, v219
    v_mfma_f32_16x16x32_bf16 v[228:231], a[40:43], v[64:67], v[228:231]
    v_exp_f32 v220, v220
    v_mfma_f32_16x16x32_bf16 v[224:227], a[44:47], v[44:47], v[224:227]
    v_exp_f32 v221, v221
    v_mfma_f32_16x16x32_bf16 v[228:231], a[44:47], v[68:71], v[228:231]
    v_exp_f32 v222, v222
    v_exp_f32 v223, v223
    v_cvt_pk_bf16_f32 v200, v216, v217
    v_cvt_pk_bf16_f32 v201, v218, v219
    v_cvt_pk_bf16_f32 v204, v220, v221
    v_cvt_pk_bf16_f32 v205, v222, v223
    v_mul_f32 v224, s40, v224
    v_mul_f32 v225, s40, v225
    v_mul_f32 v226, s40, v226
    v_mul_f32 v227, s40, v227
    v_mul_f32 v228, s40, v228
    v_mul_f32 v229, s40, v229
    v_mul_f32 v230, s40, v230
    v_mul_f32 v231, s40, v231
    v_exp_f32 v224, v224
    v_exp_f32 v225, v225
    v_exp_f32 v226, v226
    v_exp_f32 v227, v227
    v_exp_f32 v228, v228
    v_exp_f32 v229, v229
    v_exp_f32 v230, v230
    v_exp_f32 v231, v231
    v_cvt_pk_bf16_f32 v202, v224, v225
    v_cvt_pk_bf16_f32 v203, v226, v227
    v_cvt_pk_bf16_f32 v206, v228, v229
    v_cvt_pk_bf16_f32 v207, v230, v231
    s_mov_b32 s46, 0x00003f80
    s_mov_b32 s47, 0x3f800000
    s_mul_i32 s48, s33, 36864
    ds_read_b128 v[232:235], v14 offset:0
    ds_read_b128 v[236:239], v14 offset:1024
    ds_read_b128 v[240:243], v15 offset:0
    s_waitcnt lgkmcnt(0)
    v_dot2_f32_bf16 v216, v232, s46, 0
    v_dot2_f32_bf16 v217, v232, s47, 0
    v_dot2_f32_bf16 v218, v233, s46, 0
    v_dot2_f32_bf16 v219, v233, s47, 0
    v_dot2_f32_bf16 v220, v234, s46, 0
    v_dot2_f32_bf16 v221, v234, s47, 0
    v_dot2_f32_bf16 v222, v235, s46, 0
    v_dot2_f32_bf16 v223, v235, s47, 0
    s_waitcnt vmcnt(14)
    v_accvgpr_read_b32 v224, a48
    v_accvgpr_read_b32 v225, a49
    v_accvgpr_read_b32 v226, a50
    v_accvgpr_read_b32 v227, a51
    v_dot2_f32_bf16 v216, v224, s46, v216
    v_dot2_f32_bf16 v217, v224, s47, v217
    v_dot2_f32_bf16 v218, v225, s46, v218
    v_dot2_f32_bf16 v219, v225, s47, v219
    v_dot2_f32_bf16 v220, v226, s46, v220
    v_dot2_f32_bf16 v221, v226, s47, v221
    v_dot2_f32_bf16 v222, v227, s46, v222
    v_dot2_f32_bf16 v223, v227, s47, v223
    s_waitcnt vmcnt(13)
    v_accvgpr_read_b32 v224, a52
    v_accvgpr_read_b32 v225, a53
    v_accvgpr_read_b32 v226, a54
    v_accvgpr_read_b32 v227, a55
    v_dot2_f32_bf16 v216, v224, s46, v216
    v_dot2_f32_bf16 v217, v224, s47, v217
    v_dot2_f32_bf16 v218, v225, s46, v218
    v_dot2_f32_bf16 v219, v225, s47, v219
    v_dot2_f32_bf16 v220, v226, s46, v220
    v_dot2_f32_bf16 v221, v226, s47, v221
    v_dot2_f32_bf16 v222, v227, s46, v222
    v_dot2_f32_bf16 v223, v227, s47, v223
    s_waitcnt vmcnt(12)
    v_accvgpr_read_b32 v224, a56
    v_accvgpr_read_b32 v225, a57
    v_accvgpr_read_b32 v226, a58
    v_accvgpr_read_b32 v227, a59
    v_dot2_f32_bf16 v216, v224, s46, v216
    v_dot2_f32_bf16 v217, v224, s47, v217
    v_dot2_f32_bf16 v218, v225, s46, v218
    v_dot2_f32_bf16 v219, v225, s47, v219
    v_dot2_f32_bf16 v220, v226, s46, v220
    v_dot2_f32_bf16 v221, v226, s47, v221
    v_dot2_f32_bf16 v222, v227, s46, v222
    v_dot2_f32_bf16 v223, v227, s47, v223
    v_cvt_pk_bf16_f32 v228, v216, v217
    v_cvt_pk_bf16_f32 v229, v218, v219
    v_cvt_pk_bf16_f32 v230, v220, v221
    v_cvt_pk_bf16_f32 v231, v222, v223
    v_min_u32 v228, 0xfffffffe, v228
    v_min_u32 v229, 0xfffffffe, v229
    v_min_u32 v230, 0xfffffffe, v230
    v_min_u32 v231, 0xfffffffe, v231
    s_add_u32 s41, s66, s48
    buffer_store_dwordx4 v[228:231], v20, s[16:19], s41 offen sc1
    s_nop 1
    v_dot2_f32_bf16 v216, v236, s46, 0
    v_dot2_f32_bf16 v217, v236, s47, 0
    v_dot2_f32_bf16 v218, v237, s46, 0
    v_dot2_f32_bf16 v219, v237, s47, 0
    v_dot2_f32_bf16 v220, v238, s46, 0
    v_dot2_f32_bf16 v221, v238, s47, 0
    v_dot2_f32_bf16 v222, v239, s46, 0
    v_dot2_f32_bf16 v223, v239, s47, 0
    s_waitcnt vmcnt(12)
    v_accvgpr_read_b32 v224, a60
    v_accvgpr_read_b32 v225, a61
    v_accvgpr_read_b32 v226, a62
    v_accvgpr_read_b32 v227, a63
    v_dot2_f32_bf16 v216, v224, s46, v216
    v_dot2_f32_bf16 v217, v224, s47, v217
    v_dot2_f32_bf16 v218, v225, s46, v218
    v_dot2_f32_bf16 v219, v225, s47, v219
    v_dot2_f32_bf16 v220, v226, s46, v220
    v_dot2_f32_bf16 v221, v226, s47, v221
    v_dot2_f32_bf16 v222, v227, s46, v222
    v_dot2_f32_bf16 v223, v227, s47, v223
    s_waitcnt vmcnt(11)
    v_accvgpr_read_b32 v224, a64
    v_accvgpr_read_b32 v225, a65
    v_accvgpr_read_b32 v226, a66
    v_accvgpr_read_b32 v227, a67
    v_dot2_f32_bf16 v216, v224, s46, v216
    v_dot2_f32_bf16 v217, v224, s47, v217
    v_dot2_f32_bf16 v218, v225, s46, v218
    v_dot2_f32_bf16 v219, v225, s47, v219
    v_dot2_f32_bf16 v220, v226, s46, v220
    v_dot2_f32_bf16 v221, v226, s47, v221
    v_dot2_f32_bf16 v222, v227, s46, v222
    v_dot2_f32_bf16 v223, v227, s47, v223
    s_waitcnt vmcnt(10)
    v_accvgpr_read_b32 v224, a68
    v_accvgpr_read_b32 v225, a69
    v_accvgpr_read_b32 v226, a70
    v_accvgpr_read_b32 v227, a71
    v_dot2_f32_bf16 v216, v224, s46, v216
    v_dot2_f32_bf16 v217, v224, s47, v217
    v_dot2_f32_bf16 v218, v225, s46, v218
    v_dot2_f32_bf16 v219, v225, s47, v219
    v_dot2_f32_bf16 v220, v226, s46, v220
    v_dot2_f32_bf16 v221, v226, s47, v221
    v_dot2_f32_bf16 v222, v227, s46, v222
    v_dot2_f32_bf16 v223, v227, s47, v223
    v_cvt_pk_bf16_f32 v228, v216, v217
    v_cvt_pk_bf16_f32 v229, v218, v219
    v_cvt_pk_bf16_f32 v230, v220, v221
    v_cvt_pk_bf16_f32 v231, v222, v223
    v_min_u32 v228, 0xfffffffe, v228
    v_min_u32 v229, 0xfffffffe, v229
    v_min_u32 v230, 0xfffffffe, v230
    v_min_u32 v231, 0xfffffffe, v231
    s_add_u32 s41, s67, s48
    buffer_store_dwordx4 v[228:231], v20, s[16:19], s41 offen sc1
    s_nop 1
    v_dot2_f32_bf16 v216, v240, s46, 0
    v_dot2_f32_bf16 v217, v240, s47, 0
    v_dot2_f32_bf16 v218, v241, s46, 0
    v_dot2_f32_bf16 v219, v241, s47, 0
    v_dot2_f32_bf16 v220, v242, s46, 0
    v_dot2_f32_bf16 v221, v242, s47, 0
    v_dot2_f32_bf16 v222, v243, s46, 0
    v_dot2_f32_bf16 v223, v243, s47, 0
    s_waitcnt vmcnt(10)
    v_accvgpr_read_b32 v224, a72
    v_accvgpr_read_b32 v225, a73
    v_accvgpr_read_b32 v226, a74
    v_accvgpr_read_b32 v227, a75
    v_dot2_f32_bf16 v216, v224, s46, v216
    v_dot2_f32_bf16 v217, v224, s47, v217
    v_dot2_f32_bf16 v218, v225, s46, v218
    v_dot2_f32_bf16 v219, v225, s47, v219
    v_dot2_f32_bf16 v220, v226, s46, v220
    v_dot2_f32_bf16 v221, v226, s47, v221
    v_dot2_f32_bf16 v222, v227, s46, v222
    v_dot2_f32_bf16 v223, v227, s47, v223
    s_waitcnt vmcnt(9)
    v_accvgpr_read_b32 v224, a76
    v_accvgpr_read_b32 v225, a77
    v_accvgpr_read_b32 v226, a78
    v_accvgpr_read_b32 v227, a79
    v_dot2_f32_bf16 v216, v224, s46, v216
    v_dot2_f32_bf16 v217, v224, s47, v217
    v_dot2_f32_bf16 v218, v225, s46, v218
    v_dot2_f32_bf16 v219, v225, s47, v219
    v_dot2_f32_bf16 v220, v226, s46, v220
    v_dot2_f32_bf16 v221, v226, s47, v221
    v_dot2_f32_bf16 v222, v227, s46, v222
    v_dot2_f32_bf16 v223, v227, s47, v223
    s_waitcnt vmcnt(8)
    v_accvgpr_read_b32 v224, a80
    v_accvgpr_read_b32 v225, a81
    v_accvgpr_read_b32 v226, a82
    v_accvgpr_read_b32 v227, a83
    v_dot2_f32_bf16 v216, v224, s46, v216
    v_dot2_f32_bf16 v217, v224, s47, v217
    v_dot2_f32_bf16 v218, v225, s46, v218
    v_dot2_f32_bf16 v219, v225, s47, v219
    v_dot2_f32_bf16 v220, v226, s46, v220
    v_dot2_f32_bf16 v221, v226, s47, v221
    v_dot2_f32_bf16 v222, v227, s46, v222
    v_dot2_f32_bf16 v223, v227, s47, v223
    v_cvt_pk_bf16_f32 v228, v216, v217
    v_cvt_pk_bf16_f32 v229, v218, v219
    v_cvt_pk_bf16_f32 v230, v220, v221
    v_cvt_pk_bf16_f32 v231, v222, v223
    v_min_u32 v228, 0xfffffffe, v228
    v_min_u32 v229, 0xfffffffe, v229
    v_min_u32 v230, 0xfffffffe, v230
    v_min_u32 v231, 0xfffffffe, v231
    s_add_u32 s41, s68, s48
    s_mov_b64 exec, 0xffff
    buffer_store_dwordx4 v[228:231], v20, s[16:19], s41 offen sc1
    s_mov_b64 exec, -1
    s_nop 1
    s_waitcnt vmcnt(3)
    s_barrier
    s_mul_i32 s41, s24, 6144
    s_add_u32 s41, s41, 98304
    v_add_u32 v10, s41, v4
    v_add_u32 v11, s41, v5
    ds_read_b128 v[72:75], v10 offset:0
    ds_read_b128 v[76:79], v11 offset:0
    ds_read_b128 v[80:83], v10 offset:1024
    ds_read_b128 v[84:87], v11 offset:1024
    ds_read_b128 v[88:91], v10 offset:2048
    ds_read_b128 v[92:95], v11 offset:2048
    s_mul_i32 s41, s24, 6144
    s_add_u32 s41, s41, 122880
    v_add_u32 v10, s41, v4
    v_add_u32 v11, s41, v5
    ds_read_b128 v[96:99], v10 offset:0
    ds_read_b128 v[100:103], v11 offset:0
    ds_read_b128 v[104:107], v10 offset:1024
    ds_read_b128 v[108:111], v11 offset:1024
    ds_read_b128 v[112:115], v10 offset:2048
    ds_read_b128 v[116:119], v11 offset:2048
    s_waitcnt lgkmcnt(0)
    s_barrier
    v_dot2_f32_bf16 v216, v72, v72, 0
    v_dot2_f32_bf16 v224, v96, v96, 0
    v_dot2_f32_bf16 v217, v73, v73, 0
    v_dot2_f32_bf16 v225, v97, v97, 0
    v_dot2_f32_bf16 v218, v74, v74, 0
    v_dot2_f32_bf16 v226, v98, v98, 0
    v_dot2_f32_bf16 v219, v75, v75, 0
    v_dot2_f32_bf16 v227, v99, v99, 0
    v_dot2_f32_bf16 v216, v76, v76, v216
    v_dot2_f32_bf16 v224, v100, v100, v224
    v_dot2_f32_bf16 v217, v77, v77, v217
    v_dot2_f32_bf16 v225, v101, v101, v225
    v_dot2_f32_bf16 v218, v78, v78, v218
    v_dot2_f32_bf16 v226, v102, v102, v226
    v_dot2_f32_bf16 v219, v79, v79, v219
    v_dot2_f32_bf16 v227, v103, v103, v227
    v_dot2_f32_bf16 v216, v80, v80, v216
    v_dot2_f32_bf16 v224, v104, v104, v224
    v_dot2_f32_bf16 v217, v81, v81, v217
    v_dot2_f32_bf16 v225, v105, v105, v225
    v_dot2_f32_bf16 v218, v82, v82, v218
    v_dot2_f32_bf16 v226, v106, v106, v226
    v_dot2_f32_bf16 v219, v83, v83, v219
    v_dot2_f32_bf16 v227, v107, v107, v227
    v_dot2_f32_bf16 v216, v84, v84, v216
    v_dot2_f32_bf16 v224, v108, v108, v224
    v_dot2_f32_bf16 v217, v85, v85, v217
    v_dot2_f32_bf16 v225, v109, v109, v225
    v_dot2_f32_bf16 v218, v86, v86, v218
    v_dot2_f32_bf16 v226, v110, v110, v226
    v_dot2_f32_bf16 v219, v87, v87, v219
    v_dot2_f32_bf16 v227, v111, v111, v227
    v_dot2_f32_bf16 v216, v88, v88, v216
    v_dot2_f32_bf16 v224, v112, v112, v224
    v_dot2_f32_bf16 v217, v89, v89, v217
    v_dot2_f32_bf16 v225, v113, v113, v225
    v_dot2_f32_bf16 v218, v90, v90, v218
    v_dot2_f32_bf16 v226, v114, v114, v226
    v_dot2_f32_bf16 v219, v91, v91, v219
    v_dot2_f32_bf16 v227, v115, v115, v227
    v_dot2_f32_bf16 v216, v92, v92, v216
    v_dot2_f32_bf16 v224, v116, v116, v224
    v_dot2_f32_bf16 v217, v93, v93, v217
    v_dot2_f32_bf16 v225, v117, v117, v225
    v_dot2_f32_bf16 v218, v94, v94, v218
    v_dot2_f32_bf16 v226, v118, v118, v226
    v_dot2_f32_bf16 v219, v95, v95, v219
    v_dot2_f32_bf16 v227, v119, v119, v227
    v_add_f32 v216, v216, v217
    v_add_f32 v224, v224, v225
    v_add_f32 v218, v218, v219
    v_add_f32 v226, v226, v227
    v_add_f32 v216, v216, v218
    v_add_f32 v224, v224, v226
    v_mov_b32 v220, v216
    v_mov_b32 v228, v224
    s_nop 0
    v_permlane16_swap_b32 v220, v216
    v_permlane16_swap_b32 v228, v224
    v_add_f32 v216, v216, v220
    v_add_f32 v224, v224, v228
    v_mov_b32 v220, v216
    v_mov_b32 v228, v224
    s_nop 0
    v_permlane32_swap_b32 v220, v216
    v_permlane32_swap_b32 v228, v224
    v_add_f32 v216, v216, v220
    v_add_f32 v224, v224, v228
    v_mul_f32 v216, 0x3d553b95, v216
    v_mul_f32 v224, 0x3d553b95, v224
    v_add_f32 v216, 0x4072b803, v216
    v_add_f32 v224, 0x4072b803, v224
    v_mul_f32 v56, 0xc02521be, v216
    v_mul_f32 v60, 0xc02521be, v224
    v_mov_b32 v57, v56
    v_mov_b32 v61, v60
    v_mov_b32 v58, v56
    v_mov_b32 v62, v60
    v_mov_b32 v59, v56
    v_mov_b32 v63, v60
    s_mul_i32 s50, s24, 18432
    s_add_u32 s51, s50, 73728
    s_lshl_b32 s41, s25, 3
    s_mul_i32 s41, s41, 37888
    s_add_u32 s12, s30, s41
    s_addc_u32 s13, s31, 0
    s_mov_b32 s14, 303104
    s_mov_b32 s15, 0x00020000
    v_mov_b32 v22, v0
    v_cmp_le_u32 vcc, 96, v22
    s_nop 1
    v_cndmask_b32 v23, 0, 1, vcc
    v_mul_u32_u24 v14, 96, v23
    v_sub_u32 v22, v22, v14
    s_mov_b32 s41, 151552
    v_mul_lo_u32 v14, v23, s41
    v_cmp_le_u32 vcc, 48, v22
    s_nop 1
    v_cndmask_b32 v23, 0, 1, vcc
    v_mul_u32_u24 v15, 48, v23
    v_sub_u32 v22, v22, v15
    v_mul_u32_u24 v15, 192, v23
    v_add_u32 v14, v14, v15
    v_lshl_add_u32 v14, v22, 2, v14
    v_add_u32 v15, s51, v20
    ds_read_b128 a[0:3], v4 offset:0
    ds_read_b128 a[4:7], v5 offset:0
    ds_read_b128 a[8:11], v4 offset:1024
    ds_read_b128 a[12:15], v5 offset:1024
    ds_read_b128 a[16:19], v4 offset:2048
    ds_read_b128 a[20:23], v5 offset:2048
    s_waitcnt lgkmcnt(4)
    v_mfma_f32_16x16x32_bf16 v[216:219], a[0:3], v[72:75], v[56:59]
    ds_read_b128 a[24:27], v4 offset:6144
    s_add_u32 m0, s51, 0
    v_mfma_f32_16x16x32_bf16 v[220:223], a[0:3], v[96:99], v[60:63]
    ds_read_b128 a[28:31], v5 offset:6144
    s_add_u32 s41, s50, 0
    v_mfma_f32_16x16x32_bf16 v[216:219], a[4:7], v[76:79], v[216:219]
    ds_read_b128 a[32:35], v4 offset:7168
    buffer_load_dwordx4 v20, s[16:19], s41 offen sc1 lds
    v_mfma_f32_16x16x32_bf16 v[220:223], a[4:7], v[100:103], v[220:223]
    ds_read_b128 a[36:39], v5 offset:7168
    s_add_u32 m0, s51, 1024
    s_waitcnt lgkmcnt(6)
    v_mfma_f32_16x16x32_bf16 v[216:219], a[8:11], v[80:83], v[216:219]
    ds_read_b128 a[40:43], v4 offset:8192
    s_add_u32 s41, s50, 1024
    v_mfma_f32_16x16x32_bf16 v[220:223], a[8:11], v[104:107], v[220:223]
    ds_read_b128 a[44:47], v5 offset:8192
    buffer_load_dwordx4 v20, s[16:19], s41 offen sc1 lds
    v_mfma_f32_16x16x32_bf16 v[216:219], a[12:15], v[84:87], v[216:219]
    s_add_u32 m0, s51, 2048
    s_add_u32 s41, s50, 2048
    v_mfma_f32_16x16x32_bf16 v[220:223], a[12:15], v[108:111], v[220:223]
    buffer_load_dwordx4 v20, s[16:19], s41 offen sc1 lds
    s_add_u32 m0, s51, 3072
    s_waitcnt lgkmcnt(6)
    v_mfma_f32_16x16x32_bf16 v[216:219], a[16:19], v[88:91], v[216:219]
    v_mfma_f32_16x16x32_bf16 v[220:223], a[16:19], v[112:115], v[220:223]
    v_mfma_f32_16x16x32_bf16 v[216:219], a[20:23], v[92:95], v[216:219]
    v_mfma_f32_16x16x32_bf16 v[220:223], a[20:23], v[116:119], v[220:223]
    s_waitcnt lgkmcnt(4)
    v_mfma_f32_16x16x32_bf16 v[224:227], a[24:27], v[72:75], v[56:59]
    ds_read_b128 a[0:3], v4 offset:12288
    s_nop 3
    v_mul_f32 v216, s40, v216
    v_mfma_f32_16x16x32_bf16 v[228:231], a[24:27], v[96:99], v[60:63]
    s_add_u32 s41, s50, 3072
    ds_read_b128 a[4:7], v5 offset:12288
    v_mul_f32 v217, s40, v217
    v_mfma_f32_16x16x32_bf16 v[224:227], a[28:31], v[76:79], v[224:227]
    buffer_load_dwordx4 v20, s[16:19], s41 offen sc1 lds
    v_mul_f32 v218, s40, v218
    v_mfma_f32_16x16x32_bf16 v[228:231], a[28:31], v[100:103], v[228:231]
    ds_read_b128 a[8:11], v4 offset:13312
    s_waitcnt lgkmcnt(5)
    v_mul_f32 v219, s40, v219
    v_mfma_f32_16x16x32_bf16 v[224:227], a[32:35], v[80:83], v[224:227]
    s_add_u32 m0, s51, 4096
    ds_read_b128 a[12:15], v5 offset:13312
    v_mul_f32 v220, s40, v220
    v_mfma_f32_16x16x32_bf16 v[228:231], a[32:35], v[104:107], v[228:231]
    s_add_u32 s41, s50, 4096
    ds_read_b128 a[16:19], v4 offset:14336
    v_mul_f32 v221, s40, v221
    v_mfma_f32_16x16x32_bf16 v[224:227], a[36:39], v[84:87], v[224:227]
    buffer_load_dwordx4 v20, s[16:19], s41 offen sc1 lds
    v_mul_f32 v222, s40, v222
    v_mfma_f32_16x16x32_bf16 v[228:231], a[36:39], v[108:111], v[228:231]
    ds_read_b128 a[20:23], v5 offset:14336
    s_waitcnt lgkmcnt(6)
    v_mul_f32 v223, s40, v223
    v_mfma_f32_16x16x32_bf16 v[224:227], a[40:43], v[88:91], v[224:227]
    s_add_u32 m0, s51, 5120
    v_exp_f32 v216, v216
    v_mfma_f32_16x16x32_bf16 v[228:231], a[40:43], v[112:115], v[228:231]
    s_add_u32 s41, s50, 5120
    v_exp_f32 v217, v217
    v_mfma_f32_16x16x32_bf16 v[224:227], a[44:47], v[92:95], v[224:227]
    v_exp_f32 v218, v218
    v_mfma_f32_16x16x32_bf16 v[228:231], a[44:47], v[116:119], v[228:231]
    buffer_load_dwordx4 v20, s[16:19], s41 offen sc1 lds
    s_add_u32 m0, s51, 6144
    s_add_u32 s41, s50, 6144
    v_exp_f32 v219, v219
    v_exp_f32 v220, v220
    v_exp_f32 v221, v221
    v_exp_f32 v222, v222
    v_exp_f32 v223, v223
    v_cvt_pk_bf16_f32 v128, v216, v217
    v_cvt_pk_bf16_f32 v129, v218, v219
    v_cvt_pk_bf16_f32 v132, v220, v221
    v_cvt_pk_bf16_f32 v133, v222, v223
    s_waitcnt lgkmcnt(4)
    v_mfma_f32_16x16x32_bf16 v[216:219], a[0:3], v[72:75], v[56:59]
    ds_read_b128 a[24:27], v4 offset:18432
    v_mul_f32 v224, s40, v224
    v_mfma_f32_16x16x32_bf16 v[220:223], a[0:3], v[96:99], v[60:63]
    buffer_load_dwordx4 v20, s[16:19], s41 offen sc1 lds
    v_mul_f32 v225, s40, v225
    v_mfma_f32_16x16x32_bf16 v[216:219], a[4:7], v[76:79], v[216:219]
    ds_read_b128 a[28:31], v5 offset:18432
    v_mul_f32 v226, s40, v226
    v_mfma_f32_16x16x32_bf16 v[220:223], a[4:7], v[100:103], v[220:223]
    s_waitcnt lgkmcnt(4)
    v_mul_f32 v227, s40, v227
    v_mul_f32 v228, s40, v228
    v_mfma_f32_16x16x32_bf16 v[216:219], a[8:11], v[80:83], v[216:219]
    s_add_u32 m0, s51, 7168
    ds_read_b128 a[32:35], v4 offset:19456
    v_mul_f32 v229, s40, v229
    v_mfma_f32_16x16x32_bf16 v[220:223], a[8:11], v[104:107], v[220:223]
    s_add_u32 s41, s50, 7168
    ds_read_b128 a[36:39], v5 offset:19456
    v_mul_f32 v230, s40, v230
    v_mfma_f32_16x16x32_bf16 v[216:219], a[12:15], v[84:87], v[216:219]
    buffer_load_dwordx4 v20, s[16:19], s41 offen sc1 lds
    v_mul_f32 v231, s40, v231
    v_mfma_f32_16x16x32_bf16 v[220:223], a[12:15], v[108:111], v[220:223]
    s_waitcnt lgkmcnt(4)
    v_exp_f32 v224, v224
    v_mfma_f32_16x16x32_bf16 v[216:219], a[16:19], v[88:91], v[216:219]
    ds_read_b128 a[40:43], v4 offset:20480
    v_mfma_f32_16x16x32_bf16 v[220:223], a[16:19], v[112:115], v[220:223]
    s_add_u32 m0, s51, 8192
    ds_read_b128 a[44:47], v5 offset:20480
    v_mfma_f32_16x16x32_bf16 v[216:219], a[20:23], v[92:95], v[216:219]
    s_add_u32 s41, s50, 8192
    buffer_load_dwordx4 v20, s[16:19], s41 offen sc1 lds
    v_mfma_f32_16x16x32_bf16 v[220:223], a[20:23], v[116:119], v[220:223]
    s_add_u32 m0, s51, 9216
    v_exp_f32 v225, v225
    s_add_u32 s41, s50, 9216
    buffer_load_dwordx4 v20, s[16:19], s41 offen sc1 lds
    v_exp_f32 v226, v226
    v_exp_f32 v227, v227
    v_exp_f32 v228, v228
    v_exp_f32 v229, v229
    v_exp_f32 v230, v230
    v_exp_f32 v231, v231
    v_cvt_pk_bf16_f32 v130, v224, v225
    v_cvt_pk_bf16_f32 v131, v226, v227
    v_cvt_pk_bf16_f32 v134, v228, v229
    v_cvt_pk_bf16_f32 v135, v230, v231
    s_waitcnt lgkmcnt(4)
    v_mfma_f32_16x16x32_bf16 v[224:227], a[24:27], v[72:75], v[56:59]
    ds_read_b128 a[0:3], v4 offset:24576
    v_mul_f32 v216, s40, v216
    v_mfma_f32_16x16x32_bf16 v[228:231], a[24:27], v[96:99], v[60:63]
    s_add_u32 m0, s51, 10240
    ds_read_b128 a[4:7], v5 offset:24576
    v_mul_f32 v217, s40, v217
    v_mfma_f32_16x16x32_bf16 v[224:227], a[28:31], v[76:79], v[224:227]
    s_add_u32 s41, s50, 10240
    ds_read_b128 a[8:11], v4 offset:25600
    v_mul_f32 v218, s40, v218
    v_mfma_f32_16x16x32_bf16 v[228:231], a[28:31], v[100:103], v[228:231]
    buffer_load_dwordx4 v20, s[16:19], s41 offen sc1 lds
    s_waitcnt lgkmcnt(5)
    v_mul_f32 v219, s40, v219
    v_mfma_f32_16x16x32_bf16 v[224:227], a[32:35], v[80:83], v[224:227]
    ds_read_b128 a[12:15], v5 offset:25600
    v_mul_f32 v220, s40, v220
    v_mfma_f32_16x16x32_bf16 v[228:231], a[32:35], v[104:107], v[228:231]
    s_add_u32 m0, s51, 11264
    ds_read_b128 a[16:19], v4 offset:26624
    v_mul_f32 v221, s40, v221
    v_mfma_f32_16x16x32_bf16 v[224:227], a[36:39], v[84:87], v[224:227]
    s_add_u32 s41, s50, 11264
    ds_read_b128 a[20:23], v5 offset:26624
    v_mul_f32 v222, s40, v222
    v_mfma_f32_16x16x32_bf16 v[228:231], a[36:39], v[108:111], v[228:231]
    buffer_load_dwordx4 v20, s[16:19], s41 offen sc1 lds
    s_waitcnt lgkmcnt(6)
    v_mul_f32 v223, s40, v223
    v_mfma_f32_16x16x32_bf16 v[224:227], a[40:43], v[88:91], v[224:227]
    s_add_u32 m0, s51, 12288
    v_exp_f32 v216, v216
    v_mfma_f32_16x16x32_bf16 v[228:231], a[40:43], v[112:115], v[228:231]
    s_add_u32 s41, s50, 12288
    v_exp_f32 v217, v217
    v_mfma_f32_16x16x32_bf16 v[224:227], a[44:47], v[92:95], v[224:227]
    v_exp_f32 v218, v218
    v_mfma_f32_16x16x32_bf16 v[228:231], a[44:47], v[116:119], v[228:231]
    buffer_load_dwordx4 v20, s[16:19], s41 offen sc1 lds
    s_add_u32 m0, s51, 13312
    v_exp_f32 v219, v219
    v_exp_f32 v220, v220
    v_exp_f32 v221, v221
    v_exp_f32 v222, v222
    v_exp_f32 v223, v223
    v_cvt_pk_bf16_f32 v144, v216, v217
    v_cvt_pk_bf16_f32 v145, v218, v219
    v_cvt_pk_bf16_f32 v148, v220, v221
    v_cvt_pk_bf16_f32 v149, v222, v223
    s_waitcnt lgkmcnt(4)
    v_mfma_f32_16x16x32_bf16 v[216:219], a[0:3], v[72:75], v[56:59]
    ds_read_b128 a[24:27], v4 offset:30720
    v_mul_f32 v224, s40, v224
    v_mfma_f32_16x16x32_bf16 v[220:223], a[0:3], v[96:99], v[60:63]
    s_add_u32 s41, s50, 13312
    ds_read_b128 a[28:31], v5 offset:30720
    v_mul_f32 v225, s40, v225
    v_mfma_f32_16x16x32_bf16 v[216:219], a[4:7], v[76:79], v[216:219]
    buffer_load_dwordx4 v20, s[16:19], s41 offen sc1 lds
    v_mul_f32 v226, s40, v226
    v_mfma_f32_16x16x32_bf16 v[220:223], a[4:7], v[100:103], v[220:223]
    ds_read_b128 a[32:35], v4 offset:31744
    s_waitcnt lgkmcnt(5)
    v_mul_f32 v227, s40, v227
    v_mfma_f32_16x16x32_bf16 v[216:219], a[8:11], v[80:83], v[216:219]
    s_add_u32 m0, s51, 14336
    ds_read_b128 a[36:39], v5 offset:31744
    v_mul_f32 v228, s40, v228
    v_mfma_f32_16x16x32_bf16 v[220:223], a[8:11], v[104:107], v[220:223]
    s_add_u32 s41, s50, 14336
    ds_read_b128 a[40:43], v4 offset:32768
    v_mul_f32 v229, s40, v229
    v_mfma_f32_16x16x32_bf16 v[216:219], a[12:15], v[84:87], v[216:219]
    buffer_load_dwordx4 v20, s[16:19], s41 offen sc1 lds
    v_mul_f32 v230, s40, v230
    v_mfma_f32_16x16x32_bf16 v[220:223], a[12:15], v[108:111], v[220:223]
    ds_read_b128 a[44:47], v5 offset:32768
    s_waitcnt lgkmcnt(6)
    v_mul_f32 v231, s40, v231
    v_mfma_f32_16x16x32_bf16 v[216:219], a[16:19], v[88:91], v[216:219]
    s_add_u32 m0, s51, 15360
    v_exp_f32 v224, v224
    v_mfma_f32_16x16x32_bf16 v[220:223], a[16:19], v[112:115], v[220:223]
    s_add_u32 s41, s50, 15360
    v_exp_f32 v225, v225
    v_mfma_f32_16x16x32_bf16 v[216:219], a[20:23], v[92:95], v[216:219]
    v_exp_f32 v226, v226
    v_mfma_f32_16x16x32_bf16 v[220:223], a[20:23], v[116:119], v[220:223]
    buffer_load_dwordx4 v20, s[16:19], s41 offen sc1 lds
    s_add_u32 m0, s51, 16384
    s_add_u32 s41, s50, 16384
    v_exp_f32 v227, v227
    v_exp_f32 v228, v228
    v_exp_f32 v229, v229
    v_exp_f32 v230, v230
    v_exp_f32 v231, v231
    v_cvt_pk_bf16_f32 v146, v224, v225
    v_cvt_pk_bf16_f32 v147, v226, v227
    v_cvt_pk_bf16_f32 v150, v228, v229
    v_cvt_pk_bf16_f32 v151, v230, v231
    s_waitcnt lgkmcnt(4)
    v_mfma_f32_16x16x32_bf16 v[224:227], a[24:27], v[72:75], v[56:59]
    ds_read_b128 a[0:3], v4 offset:36864
    v_mul_f32 v216, s40, v216
    v_mfma_f32_16x16x32_bf16 v[228:231], a[24:27], v[96:99], v[60:63]
    buffer_load_dwordx4 v20, s[16:19], s41 offen sc1 lds
    v_mul_f32 v217, s40, v217
    v_mfma_f32_16x16x32_bf16 v[224:227], a[28:31], v[76:79], v[224:227]
    ds_read_b128 a[4:7], v5 offset:36864
    v_mul_f32 v218, s40, v218
    v_mfma_f32_16x16x32_bf16 v[228:231], a[28:31], v[100:103], v[228:231]
    s_waitcnt lgkmcnt(4)
    v_mul_f32 v219, s40, v219
    v_mul_f32 v220, s40, v220
    v_mfma_f32_16x16x32_bf16 v[224:227], a[32:35], v[80:83], v[224:227]
    s_add_u32 m0, s51, 17408
    ds_read_b128 a[8:11], v4 offset:37888
    v_mul_f32 v221, s40, v221
    v_mfma_f32_16x16x32_bf16 v[228:231], a[32:35], v[104:107], v[228:231]
    s_add_u32 s41, s50, 17408
    ds_read_b128 a[12:15], v5 offset:37888
    v_mul_f32 v222, s40, v222
    v_mfma_f32_16x16x32_bf16 v[224:227], a[36:39], v[84:87], v[224:227]
    buffer_load_dwordx4 v20, s[16:19], s41 offen sc1 lds
    v_mul_f32 v223, s40, v223
    v_mfma_f32_16x16x32_bf16 v[228:231], a[36:39], v[108:111], v[228:231]
    ds_read_b128 a[16:19], v4 offset:38912
    s_waitcnt lgkmcnt(5)
    v_mfma_f32_16x16x32_bf16 v[224:227], a[40:43], v[88:91], v[224:227]
    s_mov_b32 s41, 36864
    ds_read_b128 a[20:23], v5 offset:38912
    v_mfma_f32_16x16x32_bf16 v[228:231], a[40:43], v[112:115], v[228:231]
    buffer_load_dword a112, v14, s[12:15], s41 offen sc1
    v_mfma_f32_16x16x32_bf16 v[224:227], a[44:47], v[92:95], v[224:227]
    s_mov_b32 s41, 37248
    buffer_load_dword a113, v14, s[12:15], s41 offen sc1
    v_mfma_f32_16x16x32_bf16 v[228:231], a[44:47], v[116:119], v[228:231]
    s_mov_b32 s41, 74752
    buffer_load_dword a114, v14, s[12:15], s41 offen sc1
    v_exp_f32 v216, v216
    v_exp_f32 v217, v217
    v_exp_f32 v218, v218
    v_exp_f32 v219, v219
    v_exp_f32 v220, v220
    v_exp_f32 v221, v221
    v_exp_f32 v222, v222
    v_exp_f32 v223, v223
    v_cvt_pk_bf16_f32 v160, v216, v217
    v_cvt_pk_bf16_f32 v161, v218, v219
    v_cvt_pk_bf16_f32 v164, v220, v221
    v_cvt_pk_bf16_f32 v165, v222, v223
    s_waitcnt lgkmcnt(4)
    v_mfma_f32_16x16x32_bf16 v[216:219], a[0:3], v[72:75], v[56:59]
    s_mov_b32 s41, 75136
    buffer_load_dword a115, v14, s[12:15], s41 offen sc1
    v_mul_f32 v224, s40, v224
    v_mfma_f32_16x16x32_bf16 v[220:223], a[0:3], v[96:99], v[60:63]
    s_mov_b32 s41, 112640
    buffer_load_dword a116, v14, s[12:15], s41 offen sc1
    v_mul_f32 v225, s40, v225
    v_mfma_f32_16x16x32_bf16 v[216:219], a[4:7], v[76:79], v[216:219]
    s_mov_b32 s41, 113024
    buffer_load_dword a117, v14, s[12:15], s41 offen sc1
    v_mul_f32 v226, s40, v226
    v_mfma_f32_16x16x32_bf16 v[220:223], a[4:7], v[100:103], v[220:223]
    s_waitcnt lgkmcnt(2)
    v_mul_f32 v227, s40, v227
    v_mul_f32 v228, s40, v228
    v_mfma_f32_16x16x32_bf16 v[216:219], a[8:11], v[80:83], v[216:219]
    s_mov_b32 s41, 150528
    buffer_load_dword a118, v14, s[12:15], s41 offen sc1
    v_mul_f32 v229, s40, v229
    v_mfma_f32_16x16x32_bf16 v[220:223], a[8:11], v[104:107], v[220:223]
    s_mov_b32 s41, 150912
    buffer_load_dword a119, v14, s[12:15], s41 offen sc1
    v_mul_f32 v230, s40, v230
    v_mfma_f32_16x16x32_bf16 v[216:219], a[12:15], v[84:87], v[216:219]
    v_mul_f32 v231, s40, v231
    v_mfma_f32_16x16x32_bf16 v[220:223], a[12:15], v[108:111], v[220:223]
    s_waitcnt lgkmcnt(0)
    v_exp_f32 v224, v224
    v_mfma_f32_16x16x32_bf16 v[216:219], a[16:19], v[88:91], v[216:219]
    v_exp_f32 v225, v225
    v_mfma_f32_16x16x32_bf16 v[220:223], a[16:19], v[112:115], v[220:223]
    v_exp_f32 v226, v226
    v_mfma_f32_16x16x32_bf16 v[216:219], a[20:23], v[92:95], v[216:219]
    v_exp_f32 v227, v227
    v_mfma_f32_16x16x32_bf16 v[220:223], a[20:23], v[116:119], v[220:223]
    v_exp_f32 v228, v228
    v_exp_f32 v229, v229
    v_exp_f32 v230, v230
    v_exp_f32 v231, v231
    v_cvt_pk_bf16_f32 v162, v224, v225
    v_cvt_pk_bf16_f32 v163, v226, v227
    v_cvt_pk_bf16_f32 v166, v228, v229
    v_cvt_pk_bf16_f32 v167, v230, v231
    v_mul_f32 v216, s40, v216
    v_mul_f32 v217, s40, v217
    v_mul_f32 v218, s40, v218
    v_mul_f32 v219, s40, v219
    v_mul_f32 v220, s40, v220
    v_mul_f32 v221, s40, v221
    v_mul_f32 v222, s40, v222
    v_mul_f32 v223, s40, v223
    v_exp_f32 v216, v216
    v_exp_f32 v217, v217
    v_exp_f32 v218, v218
    v_exp_f32 v219, v219
    v_exp_f32 v220, v220
    v_exp_f32 v221, v221
    v_exp_f32 v222, v222
    v_exp_f32 v223, v223
    v_cvt_pk_bf16_f32 v176, v216, v217
    v_cvt_pk_bf16_f32 v177, v218, v219
    v_cvt_pk_bf16_f32 v180, v220, v221
    v_cvt_pk_bf16_f32 v181, v222, v223
    s_mov_b32 s52, 100000
L_KVCHK:
    s_waitcnt vmcnt(0)
    v_mov_b32 v48, 0
    ds_read_b128 v[24:27], v15 offset:0
    ds_read_b128 v[28:31], v15 offset:1024
    ds_read_b128 v[32:35], v15 offset:2048
    ds_read_b128 v[36:39], v15 offset:3072
    ds_read_b128 v[40:43], v15 offset:4096
    ds_read_b128 v[44:47], v15 offset:5120
    s_waitcnt lgkmcnt(0)
    v_max3_u32 v48, v48, v24, v25
    v_max3_u32 v48, v48, v26, v27
    v_max3_u32 v48, v48, v28, v29
    v_max3_u32 v48, v48, v30, v31
    v_max3_u32 v48, v48, v32, v33
    v_max3_u32 v48, v48, v34, v35
    v_max3_u32 v48, v48, v36, v37
    v_max3_u32 v48, v48, v38, v39
    v_max3_u32 v48, v48, v40, v41
    v_max3_u32 v48, v48, v42, v43
    v_max3_u32 v48, v48, v44, v45
    v_max3_u32 v48, v48, v46, v47
    ds_read_b128 v[24:27], v15 offset:6144
    ds_read_b128 v[28:31], v15 offset:7168
    ds_read_b128 v[32:35], v15 offset:8192
    ds_read_b128 v[36:39], v15 offset:9216
    ds_read_b128 v[40:43], v15 offset:10240
    ds_read_b128 v[44:47], v15 offset:11264
    s_waitcnt lgkmcnt(0)
    v_max3_u32 v48, v48, v24, v25
    v_max3_u32 v48, v48, v26, v27
    v_max3_u32 v48, v48, v28, v29
    v_max3_u32 v48, v48, v30, v31
    v_max3_u32 v48, v48, v32, v33
    v_max3_u32 v48, v48, v34, v35
    v_max3_u32 v48, v48, v36, v37
    v_max3_u32 v48, v48, v38, v39
    v_max3_u32 v48, v48, v40, v41
    v_max3_u32 v48, v48, v42, v43
    v_max3_u32 v48, v48, v44, v45
    v_max3_u32 v48, v48, v46, v47
    ds_read_b128 v[24:27], v15 offset:12288
    ds_read_b128 v[28:31], v15 offset:13312
    ds_read_b128 v[32:35], v15 offset:14336
    ds_read_b128 v[36:39], v15 offset:15360
    ds_read_b128 v[40:43], v15 offset:16384
    ds_read_b128 v[44:47], v15 offset:17408
    s_waitcnt lgkmcnt(0)
    v_max3_u32 v48, v48, v24, v25
    v_max3_u32 v48, v48, v26, v27
    v_max3_u32 v48, v48, v28, v29
    v_max3_u32 v48, v48, v30, v31
    v_max3_u32 v48, v48, v32, v33
    v_max3_u32 v48, v48, v34, v35
    v_max3_u32 v48, v48, v36, v37
    v_max3_u32 v48, v48, v38, v39
    v_max3_u32 v48, v48, v40, v41
    v_max3_u32 v48, v48, v42, v43
    v_max3_u32 v48, v48, v44, v45
    v_max3_u32 v48, v48, v46, v47
    v_accvgpr_read_b32 v24, a112
    v_accvgpr_read_b32 v25, a113
    v_accvgpr_read_b32 v26, a114
    v_accvgpr_read_b32 v27, a115
    v_accvgpr_read_b32 v28, a116
    v_accvgpr_read_b32 v29, a117
    v_accvgpr_read_b32 v30, a118
    v_accvgpr_read_b32 v31, a119
    v_max3_u32 v32, v24, v25, v26
    v_max3_u32 v32, v32, v27, v28
    v_max3_u32 v32, v32, v29, v30
    v_max_u32 v32, v32, v31
    v_cmp_gt_u32 vcc, 192, v0
    s_nop 1
    v_cndmask_b32 v32, 0, v32, vcc
    v_max_u32 v48, v48, v32
    v_cmp_eq_u32 vcc, -1, v48
    s_nop 3
    s_cmp_eq_u64 vcc, 0
    s_cbranch_scc1 L_KVOK
    s_sub_u32 s52, s52, 1
    s_cmp_eq_u32 s52, 0
    s_cbranch_scc1 L_KVOK
    s_add_u32 m0, s51, 0
    s_add_u32 s41, s50, 0
    buffer_load_dwordx4 v20, s[16:19], s41 offen sc1 lds
    s_add_u32 m0, s51, 1024
    s_add_u32 s41, s50, 1024
    buffer_load_dwordx4 v20, s[16:19], s41 offen sc1 lds
    s_add_u32 m0, s51, 2048
    s_add_u32 s41, s50, 2048
    buffer_load_dwordx4 v20, s[16:19], s41 offen sc1 lds
    s_add_u32 m0, s51, 3072
    s_add_u32 s41, s50, 3072
    buffer_load_dwordx4 v20, s[16:19], s41 offen sc1 lds
    s_add_u32 m0, s51, 4096
    s_add_u32 s41, s50, 4096
    buffer_load_dwordx4 v20, s[16:19], s41 offen sc1 lds
    s_add_u32 m0, s51, 5120
    s_add_u32 s41, s50, 5120
    buffer_load_dwordx4 v20, s[16:19], s41 offen sc1 lds
    s_add_u32 m0, s51, 6144
    s_add_u32 s41, s50, 6144
    buffer_load_dwordx4 v20, s[16:19], s41 offen sc1 lds
    s_add_u32 m0, s51, 7168
    s_add_u32 s41, s50, 7168
    buffer_load_dwordx4 v20, s[16:19], s41 offen sc1 lds
    s_add_u32 m0, s51, 8192
    s_add_u32 s41, s50, 8192
    buffer_load_dwordx4 v20, s[16:19], s41 offen sc1 lds
    s_add_u32 m0, s51, 9216
    s_add_u32 s41, s50, 9216
    buffer_load_dwordx4 v20, s[16:19], s41 offen sc1 lds
    s_add_u32 m0, s51, 10240
    s_add_u32 s41, s50, 10240
    buffer_load_dwordx4 v20, s[16:19], s41 offen sc1 lds
    s_add_u32 m0, s51, 11264
    s_add_u32 s41, s50, 11264
    buffer_load_dwordx4 v20, s[16:19], s41 offen sc1 lds
    s_add_u32 m0, s51, 12288
    s_add_u32 s41, s50, 12288
    buffer_load_dwordx4 v20, s[16:19], s41 offen sc1 lds
    s_add_u32 m0, s51, 13312
    s_add_u32 s41, s50, 13312
    buffer_load_dwordx4 v20, s[16:19], s41 offen sc1 lds
    s_add_u32 m0, s51, 14336
    s_add_u32 s41, s50, 14336
    buffer_load_dwordx4 v20, s[16:19], s41 offen sc1 lds
    s_add_u32 m0, s51, 15360
    s_add_u32 s41, s50, 15360
    buffer_load_dwordx4 v20, s[16:19], s41 offen sc1 lds
    s_add_u32 m0, s51, 16384
    s_add_u32 s41, s50, 16384
    buffer_load_dwordx4 v20, s[16:19], s41 offen sc1 lds
    s_add_u32 m0, s51, 17408
    s_add_u32 s41, s50, 17408
    buffer_load_dwordx4 v20, s[16:19], s41 offen sc1 lds
    s_mov_b32 s41, 36864
    buffer_load_dword a112, v14, s[12:15], s41 offen sc1
    s_mov_b32 s41, 37248
    buffer_load_dword a113, v14, s[12:15], s41 offen sc1
    s_mov_b32 s41, 74752
    buffer_load_dword a114, v14, s[12:15], s41 offen sc1
    s_mov_b32 s41, 75136
    buffer_load_dword a115, v14, s[12:15], s41 offen sc1
    s_mov_b32 s41, 112640
    buffer_load_dword a116, v14, s[12:15], s41 offen sc1
    s_mov_b32 s41, 113024
    buffer_load_dword a117, v14, s[12:15], s41 offen sc1
    s_mov_b32 s41, 150528
    buffer_load_dword a118, v14, s[12:15], s41 offen sc1
    s_mov_b32 s41, 150912
    buffer_load_dword a119, v14, s[12:15], s41 offen sc1
    s_branch L_KVCHK
L_KVOK:
    v_add_f32 v24, v24, v25
    v_add_f32 v24, v24, v26
    v_add_f32 v24, v24, v27
    v_add_f32 v24, v24, v28
    v_add_f32 v24, v24, v29
    v_add_f32 v24, v24, v30
    v_add_f32 v24, v24, v31
    v_cvt_pk_bf16_f32 v24, v24, v24
    v_lshlrev_b32 v22, 1, v0
    v_add_u32 v22, 160256, v22
    v_cmp_gt_u32 vcc, 192, v0
    s_nop 3
    s_and_saveexec_b64 s[46:47], vcc
    ds_write_b16 v22, v24
    s_mov_b64 exec, -1
    ds_read_b128 a[24:27], v4 offset:43008
    ds_read_b128 a[28:31], v5 offset:43008
    ds_read_b128 a[32:35], v4 offset:44032
    ds_read_b128 a[36:39], v5 offset:44032
    ds_read_b128 a[40:43], v4 offset:45056
    ds_read_b128 a[44:47], v5 offset:45056
    s_waitcnt lgkmcnt(4)
    v_mfma_f32_16x16x32_bf16 v[224:227], a[24:27], v[72:75], v[56:59]
    ds_read_b128 a[0:3], v12 offset:0
    ds_read_b128 a[4:7], v13 offset:0
    v_mfma_f32_16x16x32_bf16 v[228:231], a[24:27], v[96:99], v[60:63]
    ds_read_b128 a[8:11], v12 offset:1024
    ds_read_b128 a[12:15], v13 offset:1024
    v_mfma_f32_16x16x32_bf16 v[224:227], a[28:31], v[76:79], v[224:227]
    ds_read_b128 a[16:19], v12 offset:2048
    ds_read_b128 a[20:23], v13 offset:2048
    v_mfma_f32_16x16x32_bf16 v[228:231], a[28:31], v[100:103], v[228:231]
    s_waitcnt lgkmcnt(8)
    v_mfma_f32_16x16x32_bf16 v[224:227], a[32:35], v[80:83], v[224:227]
    v_mfma_f32_16x16x32_bf16 v[228:231], a[32:35], v[104:107], v[228:231]
    v_mfma_f32_16x16x32_bf16 v[224:227], a[36:39], v[84:87], v[224:227]
    v_mfma_f32_16x16x32_bf16 v[228:231], a[36:39], v[108:111], v[228:231]
    s_waitcnt lgkmcnt(6)
    v_mfma_f32_16x16x32_bf16 v[224:227], a[40:43], v[88:91], v[224:227]
    v_mfma_f32_16x16x32_bf16 v[228:231], a[40:43], v[112:115], v[228:231]
    v_mfma_f32_16x16x32_bf16 v[224:227], a[44:47], v[92:95], v[224:227]
    v_mfma_f32_16x16x32_bf16 v[228:231], a[44:47], v[116:119], v[228:231]
    s_waitcnt lgkmcnt(4)
    v_mfma_f32_16x16x32_bf16 v[216:219], a[0:3], v[72:75], v[56:59]
    ds_read_b128 a[24:27], v12 offset:6144
    s_nop 3
    v_mul_f32 v224, s40, v224
    v_mfma_f32_16x16x32_bf16 v[220:223], a[0:3], v[96:99], v[60:63]
    ds_read_b128 a[28:31], v13 offset:6144
    v_mul_f32 v225, s40, v225
    v_mfma_f32_16x16x32_bf16 v[216:219], a[4:7], v[76:79], v[216:219]
    ds_read_b128 a[32:35], v12 offset:7168
    v_mul_f32 v226, s40, v226
    v_mfma_f32_16x16x32_bf16 v[220:223], a[4:7], v[100:103], v[220:223]
    ds_read_b128 a[36:39], v13 offset:7168
    s_waitcnt lgkmcnt(6)
    v_mul_f32 v227, s40, v227
    v_mfma_f32_16x16x32_bf16 v[216:219], a[8:11], v[80:83], v[216:219]
    ds_read_b128 a[40:43], v12 offset:8192
    v_mul_f32 v228, s40, v228
    v_mfma_f32_16x16x32_bf16 v[220:223], a[8:11], v[104:107], v[220:223]
    ds_read_b128 a[44:47], v13 offset:8192
    v_mul_f32 v229, s40, v229
    v_mfma_f32_16x16x32_bf16 v[216:219], a[12:15], v[84:87], v[216:219]
    v_mul_f32 v230, s40, v230
    v_mul_f32 v231, s40, v231
    v_mfma_f32_16x16x32_bf16 v[220:223], a[12:15], v[108:111], v[220:223]
    s_waitcnt lgkmcnt(6)
    v_exp_f32 v224, v224
    v_mfma_f32_16x16x32_bf16 v[216:219], a[16:19], v[88:91], v[216:219]
    v_exp_f32 v225, v225
    v_mfma_f32_16x16x32_bf16 v[220:223], a[16:19], v[112:115], v[220:223]
    v_exp_f32 v226, v226
    v_mfma_f32_16x16x32_bf16 v[216:219], a[20:23], v[92:95], v[216:219]
    v_exp_f32 v227, v227
    v_mfma_f32_16x16x32_bf16 v[220:223], a[20:23], v[116:119], v[220:223]
    v_exp_f32 v228, v228
    v_exp_f32 v229, v229
    v_exp_f32 v230, v230
    v_exp_f32 v231, v231
    v_cvt_pk_bf16_f32 v178, v224, v225
    v_cvt_pk_bf16_f32 v179, v226, v227
    v_cvt_pk_bf16_f32 v182, v228, v229
    v_cvt_pk_bf16_f32 v183, v230, v231
    s_waitcnt lgkmcnt(4)
    v_mfma_f32_16x16x32_bf16 v[224:227], a[24:27], v[72:75], v[56:59]
    ds_read_b128 a[0:3], v12 offset:12288
    v_mul_f32 v216, s40, v216
    v_mfma_f32_16x16x32_bf16 v[228:231], a[24:27], v[96:99], v[60:63]
    ds_read_b128 a[4:7], v13 offset:12288
    v_mul_f32 v217, s40, v217
    v_mfma_f32_16x16x32_bf16 v[224:227], a[28:31], v[76:79], v[224:227]
    ds_read_b128 a[8:11], v12 offset:13312
    v_mul_f32 v218, s40, v218
    v_mfma_f32_16x16x32_bf16 v[228:231], a[28:31], v[100:103], v[228:231]
    ds_read_b128 a[12:15], v13 offset:13312
    s_waitcnt lgkmcnt(6)
    v_mul_f32 v219, s40, v219
    v_mfma_f32_16x16x32_bf16 v[224:227], a[32:35], v[80:83], v[224:227]
    ds_read_b128 a[16:19], v12 offset:14336
    v_mul_f32 v220, s40, v220
    v_mfma_f32_16x16x32_bf16 v[228:231], a[32:35], v[104:107], v[228:231]
    ds_read_b128 a[20:23], v13 offset:14336
    v_mul_f32 v221, s40, v221
    v_mfma_f32_16x16x32_bf16 v[224:227], a[36:39], v[84:87], v[224:227]
    v_mul_f32 v222, s40, v222
    v_mul_f32 v223, s40, v223
    v_mfma_f32_16x16x32_bf16 v[228:231], a[36:39], v[108:111], v[228:231]
    s_waitcnt lgkmcnt(6)
    v_exp_f32 v216, v216
    v_mfma_f32_16x16x32_bf16 v[224:227], a[40:43], v[88:91], v[224:227]
    v_exp_f32 v217, v217
    v_mfma_f32_16x16x32_bf16 v[228:231], a[40:43], v[112:115], v[228:231]
    v_exp_f32 v218, v218
    v_mfma_f32_16x16x32_bf16 v[224:227], a[44:47], v[92:95], v[224:227]
    v_exp_f32 v219, v219
    v_mfma_f32_16x16x32_bf16 v[228:231], a[44:47], v[116:119], v[228:231]
    v_exp_f32 v220, v220
    v_exp_f32 v221, v221
    v_exp_f32 v222, v222
    v_exp_f32 v223, v223
    v_cvt_pk_bf16_f32 v192, v216, v217
    v_cvt_pk_bf16_f32 v193, v218, v219
    v_cvt_pk_bf16_f32 v196, v220, v221
    v_cvt_pk_bf16_f32 v197, v222, v223
    s_waitcnt lgkmcnt(4)
    v_mfma_f32_16x16x32_bf16 v[216:219], a[0:3], v[72:75], v[56:59]
    ds_read_b128 a[24:27], v12 offset:18432
    v_mul_f32 v224, s40, v224
    v_mfma_f32_16x16x32_bf16 v[220:223], a[0:3], v[96:99], v[60:63]
    ds_read_b128 a[28:31], v13 offset:18432
    v_mul_f32 v225, s40, v225
    v_mfma_f32_16x16x32_bf16 v[216:219], a[4:7], v[76:79], v[216:219]
    ds_read_b128 a[32:35], v12 offset:19456
    v_mul_f32 v226, s40, v226
    v_mfma_f32_16x16x32_bf16 v[220:223], a[4:7], v[100:103], v[220:223]
    ds_read_b128 a[36:39], v13 offset:19456
    s_waitcnt lgkmcnt(6)
    v_mul_f32 v227, s40, v227
    v_mfma_f32_16x16x32_bf16 v[216:219], a[8:11], v[80:83], v[216:219]
    ds_read_b128 a[40:43], v12 offset:20480
    v_mul_f32 v228, s40, v228
    v_mfma_f32_16x16x32_bf16 v[220:223], a[8:11], v[104:107], v[220:223]
    ds_read_b128 a[44:47], v13 offset:20480
    v_mul_f32 v229, s40, v229
    v_mfma_f32_16x16x32_bf16 v[216:219], a[12:15], v[84:87], v[216:219]
    v_mul_f32 v230, s40, v230
    v_mul_f32 v231, s40, v231
    v_mfma_f32_16x16x32_bf16 v[220:223], a[12:15], v[108:111], v[220:223]
    s_waitcnt lgkmcnt(6)
    v_exp_f32 v224, v224
    v_mfma_f32_16x16x32_bf16 v[216:219], a[16:19], v[88:91], v[216:219]
    v_exp_f32 v225, v225
    v_mfma_f32_16x16x32_bf16 v[220:223], a[16:19], v[112:115], v[220:223]
    v_exp_f32 v226, v226
    v_mfma_f32_16x16x32_bf16 v[216:219], a[20:23], v[92:95], v[216:219]
    v_exp_f32 v227, v227
    v_mfma_f32_16x16x32_bf16 v[220:223], a[20:23], v[116:119], v[220:223]
    v_exp_f32 v228, v228
    v_exp_f32 v229, v229
    v_exp_f32 v230, v230
    v_exp_f32 v231, v231
    v_cvt_pk_bf16_f32 v194, v224, v225
    v_cvt_pk_bf16_f32 v195, v226, v227
    v_cvt_pk_bf16_f32 v198, v228, v229
    v_cvt_pk_bf16_f32 v199, v230, v231
    s_waitcnt lgkmcnt(4)
    v_mfma_f32_16x16x32_bf16 v[224:227], a[24:27], v[72:75], v[56:59]
    v_mul_f32 v216, s40, v216
    v_mul_f32 v217, s40, v217
    v_mfma_f32_16x16x32_bf16 v[228:231], a[24:27], v[96:99], v[60:63]
    v_mul_f32 v218, s40, v218
    v_mul_f32 v219, s40, v219
    v_mfma_f32_16x16x32_bf16 v[224:227], a[28:31], v[76:79], v[224:227]
    v_mul_f32 v220, s40, v220
    v_mul_f32 v221, s40, v221
    v_mfma_f32_16x16x32_bf16 v[228:231], a[28:31], v[100:103], v[228:231]
    s_waitcnt lgkmcnt(2)
    v_mul_f32 v222, s40, v222
    v_mul_f32 v223, s40, v223
    v_mfma_f32_16x16x32_bf16 v[224:227], a[32:35], v[80:83], v[224:227]
    v_exp_f32 v216, v216
    v_mfma_f32_16x16x32_bf16 v[228:231], a[32:35], v[104:107], v[228:231]
    v_exp_f32 v217, v217
    v_mfma_f32_16x16x32_bf16 v[224:227], a[36:39], v[84:87], v[224:227]
    v_exp_f32 v218, v218
    v_mfma_f32_16x16x32_bf16 v[228:231], a[36:39], v[108:111], v[228:231]
    s_waitcnt lgkmcnt(0)
    v_exp_f32 v219, v219
    v_mfma_f32_16x16x32_bf16 v[224:227], a[40:43], v[88:91], v[224:227]
    v_exp_f32 v220, v220
    v_mfma_f32_16x16x32_bf16 v[228:231], a[40:43], v[112:115], v[228:231]
    v_exp_f32 v221, v221
    v_mfma_f32_16x16x32_bf16 v[224:227], a[44:47], v[92:95], v[224:227]
    v_exp_f32 v222, v222
    v_mfma_f32_16x16x32_bf16 v[228:231], a[44:47], v[116:119], v[228:231]
    v_exp_f32 v223, v223
    v_cvt_pk_bf16_f32 v208, v216, v217
    v_cvt_pk_bf16_f32 v209, v218, v219
    v_cvt_pk_bf16_f32 v212, v220, v221
    v_cvt_pk_bf16_f32 v213, v222, v223
    s_nop 0
    v_mul_f32 v224, s40, v224
    v_mul_f32 v225, s40, v225
    v_mul_f32 v226, s40, v226
    v_mul_f32 v227, s40, v227
    v_mul_f32 v228, s40, v228
    v_mul_f32 v229, s40, v229
    v_mul_f32 v230, s40, v230
    v_mul_f32 v231, s40, v231
    v_exp_f32 v224, v224
    v_exp_f32 v225, v225
    v_exp_f32 v226, v226
    v_exp_f32 v227, v227
    v_exp_f32 v228, v228
    v_exp_f32 v229, v229
    v_exp_f32 v230, v230
    v_exp_f32 v231, v231
    v_cvt_pk_bf16_f32 v210, v224, v225
    v_cvt_pk_bf16_f32 v211, v226, v227
    v_cvt_pk_bf16_f32 v214, v228, v229
    v_cvt_pk_bf16_f32 v215, v230, v231
    s_waitcnt lgkmcnt(0)
    s_barrier
    v_add_u32 v10, 73728, v20
    v_add_u32 v11, 110592, v20
    v_lshrrev_b32 v22, 4, v1
    v_lshlrev_b32 v22, 3, v22
    v_add_u32 v12, 160256, v22
    ds_read_b64 a[0:1], v12 offset:0
    ds_read_b64 a[2:3], v12 offset:32
    ds_read_b64 a[4:5], v12 offset:64
    ds_read_b64 a[6:7], v12 offset:96
    ds_read_b64 a[8:9], v12 offset:128
    ds_read_b64 a[10:11], v12 offset:160
    ds_read_b64 a[12:13], v12 offset:192
    ds_read_b64 a[14:15], v12 offset:224
    ds_read_b64 a[16:17], v12 offset:256
    ds_read_b64 a[18:19], v12 offset:288
    ds_read_b64 a[20:21], v12 offset:320
    ds_read_b64 a[22:23], v12 offset:352
    s_mul_i32 s43, s24, 6144
    s_add_u32 s66, s43, 0
    s_add_u32 s67, s43, 24576
    s_add_u32 s68, s43, 49152
    s_add_u32 s69, s43, 73728
    s_waitcnt lgkmcnt(10)
    v_mfma_f32_16x16x32_bf16 v[216:219], a[0:3], v[120:123], 0
    ds_read_b128 a[48:51], v10 offset:0
    ds_read_b128 a[52:55], v10 offset:12288
    v_mfma_f32_16x16x32_bf16 v[220:223], a[0:3], v[124:127], 0
    ds_read_b128 a[56:59], v10 offset:24576
    ds_read_b128 a[60:63], v11 offset:0
    v_mfma_f32_16x16x32_bf16 v[224:227], a[0:3], v[128:131], 0
    ds_read_b128 a[64:67], v11 offset:12288
    ds_read_b128 a[68:71], v11 offset:24576
    v_mfma_f32_16x16x32_bf16 v[228:231], a[0:3], v[132:135], 0
    ds_read_b128 a[72:75], v10 offset:1024
    ds_read_b128 a[76:79], v10 offset:13312
    s_waitcnt lgkmcnt(15)
    v_mfma_f32_16x16x32_bf16 v[216:219], a[4:7], v[136:139], v[216:219]
    ds_read_b128 a[80:83], v10 offset:25600
    ds_read_b128 a[84:87], v11 offset:1024
    v_mfma_f32_16x16x32_bf16 v[220:223], a[4:7], v[140:143], v[220:223]
    ds_read_b128 a[88:91], v11 offset:13312
    ds_read_b128 a[92:95], v11 offset:25600
    v_mfma_f32_16x16x32_bf16 v[224:227], a[4:7], v[144:147], v[224:227]
    v_mfma_f32_16x16x32_bf16 v[228:231], a[4:7], v[148:151], v[228:231]
    s_waitcnt lgkmcnt(15)
    v_mfma_f32_16x16x32_bf16 v[216:219], a[8:11], v[152:155], v[216:219]
    v_mfma_f32_16x16x32_bf16 v[220:223], a[8:11], v[156:159], v[220:223]
    v_mfma_f32_16x16x32_bf16 v[224:227], a[8:11], v[160:163], v[224:227]
    v_mfma_f32_16x16x32_bf16 v[228:231], a[8:11], v[164:167], v[228:231]
    v_mfma_f32_16x16x32_bf16 v[216:219], a[12:15], v[168:171], v[216:219]
    v_mfma_f32_16x16x32_bf16 v[220:223], a[12:15], v[172:175], v[220:223]
    v_mfma_f32_16x16x32_bf16 v[224:227], a[12:15], v[176:179], v[224:227]
    v_mfma_f32_16x16x32_bf16 v[228:231], a[12:15], v[180:183], v[228:231]
    s_waitcnt lgkmcnt(14)
    v_mfma_f32_16x16x32_bf16 v[216:219], a[16:19], v[184:187], v[216:219]
    v_mfma_f32_16x16x32_bf16 v[220:223], a[16:19], v[188:191], v[220:223]
    v_mfma_f32_16x16x32_bf16 v[224:227], a[16:19], v[192:195], v[224:227]
    v_mfma_f32_16x16x32_bf16 v[228:231], a[16:19], v[196:199], v[228:231]
    s_waitcnt lgkmcnt(12)
    v_mfma_f32_16x16x32_bf16 v[216:219], a[20:23], v[200:203], v[216:219]
    v_mfma_f32_16x16x32_bf16 v[220:223], a[20:23], v[204:207], v[220:223]
    v_mfma_f32_16x16x32_bf16 v[224:227], a[20:23], v[208:211], v[224:227]
    v_mfma_f32_16x16x32_bf16 v[228:231], a[20:23], v[212:215], v[228:231]
    s_nop 4
    v_add_f32 v248, 0x358637bd, v216
    v_add_f32 v249, 0x358637bd, v220
    v_add_f32 v250, 0x358637bd, v224
    v_add_f32 v251, 0x358637bd, v228
    v_rcp_f32 v248, v248
    v_rcp_f32 v249, v249
    v_rcp_f32 v250, v250
    v_rcp_f32 v251, v251
    v_subrev_u32 v21, 64, v21
    s_mov_b32 s63, 0
    s_mov_b32 s58, 0
    s_waitcnt lgkmcnt(0)
L_FINL:
    s_waitcnt lgkmcnt(11)
    v_mfma_f32_16x16x32_bf16 v[24:27], a[48:51], v[120:123], 0
    ds_read_b128 a[96:99], v10 offset:2048
    v_mul_f32 v56, v56, v248
    v_mfma_f32_16x16x32_bf16 v[28:31], a[48:51], v[124:127], 0
    ds_read_b128 a[100:103], v10 offset:14336
    v_mul_f32 v57, v57, v248
    v_mfma_f32_16x16x32_bf16 v[32:35], a[48:51], v[128:131], 0
    ds_read_b128 a[104:107], v10 offset:26624
    v_mul_f32 v58, v58, v248
    v_mfma_f32_16x16x32_bf16 v[36:39], a[48:51], v[132:135], 0
    ds_read_b128 a[108:111], v11 offset:2048
    s_waitcnt lgkmcnt(14)
    v_mul_f32 v59, v59, v248
    v_mfma_f32_16x16x32_bf16 v[24:27], a[52:55], v[136:139], v[24:27]
    ds_read_b128 a[112:115], v11 offset:14336
    v_cvt_pk_bf16_f32 v104, v56, v57
    v_mfma_f32_16x16x32_bf16 v[28:31], a[52:55], v[140:143], v[28:31]
    ds_read_b128 a[116:119], v11 offset:26624
    v_cvt_pk_bf16_f32 v105, v58, v59
    v_mfma_f32_16x16x32_bf16 v[32:35], a[52:55], v[144:147], v[32:35]
    ds_read_b128 a[120:123], v10 offset:3072
    v_mul_f32 v72, v72, v248
    v_mfma_f32_16x16x32_bf16 v[36:39], a[52:55], v[148:151], v[36:39]
    ds_read_b128 a[124:127], v10 offset:15360
    s_waitcnt lgkmcnt(15)
    v_mul_f32 v73, v73, v248
    v_mfma_f32_16x16x32_bf16 v[24:27], a[56:59], v[152:155], v[24:27]
    ds_read_b128 a[128:131], v10 offset:27648
    v_mul_f32 v74, v74, v248
    v_mfma_f32_16x16x32_bf16 v[28:31], a[56:59], v[156:159], v[28:31]
    ds_read_b128 a[132:135], v11 offset:3072
    v_mul_f32 v75, v75, v248
    v_mfma_f32_16x16x32_bf16 v[32:35], a[56:59], v[160:163], v[32:35]
    ds_read_b128 a[136:139], v11 offset:15360
    v_cvt_pk_bf16_f32 v106, v72, v73
    v_mfma_f32_16x16x32_bf16 v[36:39], a[56:59], v[164:167], v[36:39]
    ds_read_b128 a[140:143], v11 offset:27648
    v_cvt_pk_bf16_f32 v107, v74, v75
    v_mfma_f32_16x16x32_bf16 v[24:27], a[60:63], v[168:171], v[24:27]
    v_permlane16_swap_b32 v104, v106
    v_mfma_f32_16x16x32_bf16 v[28:31], a[60:63], v[172:175], v[28:31]
    v_permlane16_swap_b32 v105, v107
    v_mfma_f32_16x16x32_bf16 v[32:35], a[60:63], v[176:179], v[32:35]
    buffer_store_dwordx4 v[104:107], v21, s[56:59], s66 offen offset:0 sc1
    v_mul_f32 v60, v60, v249
    v_mfma_f32_16x16x32_bf16 v[36:39], a[60:63], v[180:183], v[36:39]
    v_mul_f32 v61, v61, v249
    v_mul_f32 v62, v62, v249
    v_mfma_f32_16x16x32_bf16 v[24:27], a[64:67], v[184:187], v[24:27]
    v_mul_f32 v63, v63, v249
    v_cvt_pk_bf16_f32 v108, v60, v61
    v_mfma_f32_16x16x32_bf16 v[28:31], a[64:67], v[188:191], v[28:31]
    v_cvt_pk_bf16_f32 v109, v62, v63
    v_mul_f32 v76, v76, v249
    v_mfma_f32_16x16x32_bf16 v[32:35], a[64:67], v[192:195], v[32:35]
    v_mul_f32 v77, v77, v249
    v_mul_f32 v78, v78, v249
    v_mfma_f32_16x16x32_bf16 v[36:39], a[64:67], v[196:199], v[36:39]
    s_waitcnt lgkmcnt(15)
    v_mul_f32 v79, v79, v249
    v_cvt_pk_bf16_f32 v110, v76, v77
    v_mfma_f32_16x16x32_bf16 v[24:27], a[68:71], v[200:203], v[24:27]
    v_cvt_pk_bf16_f32 v111, v78, v79
    v_mfma_f32_16x16x32_bf16 v[28:31], a[68:71], v[204:207], v[28:31]
    v_permlane16_swap_b32 v108, v110
    v_mfma_f32_16x16x32_bf16 v[32:35], a[68:71], v[208:211], v[32:35]
    v_permlane16_swap_b32 v109, v111
    v_mfma_f32_16x16x32_bf16 v[36:39], a[68:71], v[212:215], v[36:39]
    buffer_store_dwordx4 v[108:111], v21, s[56:59], s67 offen offset:0 sc1
    v_mul_f32 v64, v64, v250
    v_mfma_f32_16x16x32_bf16 v[40:43], a[72:75], v[120:123], 0
    v_mul_f32 v65, v65, v250
    v_mul_f32 v66, v66, v250
    v_mfma_f32_16x16x32_bf16 v[44:47], a[72:75], v[124:127], 0
    v_mul_f32 v67, v67, v250
    v_cvt_pk_bf16_f32 v112, v64, v65
    v_mfma_f32_16x16x32_bf16 v[48:51], a[72:75], v[128:131], 0
    v_cvt_pk_bf16_f32 v113, v66, v67
    v_mul_f32 v80, v80, v250
    v_mfma_f32_16x16x32_bf16 v[52:55], a[72:75], v[132:135], 0
    v_mul_f32 v81, v81, v250
    v_mul_f32 v82, v82, v250
    v_mfma_f32_16x16x32_bf16 v[40:43], a[76:79], v[136:139], v[40:43]
    v_mul_f32 v83, v83, v250
    v_cvt_pk_bf16_f32 v114, v80, v81
    v_mfma_f32_16x16x32_bf16 v[44:47], a[76:79], v[140:143], v[44:47]
    v_cvt_pk_bf16_f32 v115, v82, v83
    v_mfma_f32_16x16x32_bf16 v[48:51], a[76:79], v[144:147], v[48:51]
    v_permlane16_swap_b32 v112, v114
    v_mfma_f32_16x16x32_bf16 v[52:55], a[76:79], v[148:151], v[52:55]
    v_permlane16_swap_b32 v113, v115
    v_mfma_f32_16x16x32_bf16 v[40:43], a[80:83], v[152:155], v[40:43]
    buffer_store_dwordx4 v[112:115], v21, s[56:59], s68 offen offset:0 sc1
    v_mul_f32 v68, v68, v251
    v_mfma_f32_16x16x32_bf16 v[44:47], a[80:83], v[156:159], v[44:47]
    v_mul_f32 v69, v69, v251
    v_mul_f32 v70, v70, v251
    v_mfma_f32_16x16x32_bf16 v[48:51], a[80:83], v[160:163], v[48:51]
    v_mul_f32 v71, v71, v251
    v_cvt_pk_bf16_f32 v116, v68, v69
    v_mfma_f32_16x16x32_bf16 v[52:55], a[80:83], v[164:167], v[52:55]
    s_waitcnt lgkmcnt(14)
    v_cvt_pk_bf16_f32 v117, v70, v71
    v_mul_f32 v84, v84, v251
    v_mfma_f32_16x16x32_bf16 v[40:43], a[84:87], v[168:171], v[40:43]
    v_mul_f32 v85, v85, v251
    v_mul_f32 v86, v86, v251
    v_mfma_f32_16x16x32_bf16 v[44:47], a[84:87], v[172:175], v[44:47]
    v_mul_f32 v87, v87, v251
    v_cvt_pk_bf16_f32 v118, v84, v85
    v_mfma_f32_16x16x32_bf16 v[48:51], a[84:87], v[176:179], v[48:51]
    v_cvt_pk_bf16_f32 v119, v86, v87
    v_mfma_f32_16x16x32_bf16 v[52:55], a[84:87], v[180:183], v[52:55]
    s_waitcnt lgkmcnt(13)
    v_permlane16_swap_b32 v116, v118
    v_mfma_f32_16x16x32_bf16 v[40:43], a[88:91], v[184:187], v[40:43]
    v_permlane16_swap_b32 v117, v119
    v_mfma_f32_16x16x32_bf16 v[44:47], a[88:91], v[188:191], v[44:47]
    buffer_store_dwordx4 v[116:119], v21, s[56:59], s69 offen offset:0 sc1
    v_mfma_f32_16x16x32_bf16 v[48:51], a[88:91], v[192:195], v[48:51]
    v_mfma_f32_16x16x32_bf16 v[52:55], a[88:91], v[196:199], v[52:55]
    s_waitcnt lgkmcnt(12)
    v_mfma_f32_16x16x32_bf16 v[40:43], a[92:95], v[200:203], v[40:43]
    v_mfma_f32_16x16x32_bf16 v[44:47], a[92:95], v[204:207], v[44:47]
    v_mfma_f32_16x16x32_bf16 v[48:51], a[92:95], v[208:211], v[48:51]
    v_mfma_f32_16x16x32_bf16 v[52:55], a[92:95], v[212:215], v[52:55]
    s_mov_b32 s58, 98304
    s_waitcnt lgkmcnt(11)
    v_mfma_f32_16x16x32_bf16 v[56:59], a[96:99], v[120:123], 0
    ds_read_b128 a[48:51], v10 offset:4096
    v_mul_f32 v24, v24, v248
    v_mfma_f32_16x16x32_bf16 v[60:63], a[96:99], v[124:127], 0
    ds_read_b128 a[52:55], v10 offset:16384
    v_mul_f32 v25, v25, v248
    v_mfma_f32_16x16x32_bf16 v[64:67], a[96:99], v[128:131], 0
    ds_read_b128 a[56:59], v10 offset:28672
    v_mul_f32 v26, v26, v248
    v_mfma_f32_16x16x32_bf16 v[68:71], a[96:99], v[132:135], 0
    ds_read_b128 a[60:63], v11 offset:4096
    s_waitcnt lgkmcnt(14)
    v_mul_f32 v27, v27, v248
    v_mfma_f32_16x16x32_bf16 v[56:59], a[100:103], v[136:139], v[56:59]
    ds_read_b128 a[64:67], v11 offset:16384
    v_cvt_pk_bf16_f32 v88, v24, v25
    v_mfma_f32_16x16x32_bf16 v[60:63], a[100:103], v[140:143], v[60:63]
    ds_read_b128 a[68:71], v11 offset:28672
    v_cvt_pk_bf16_f32 v89, v26, v27
    v_mfma_f32_16x16x32_bf16 v[64:67], a[100:103], v[144:147], v[64:67]
    ds_read_b128 a[72:75], v10 offset:5120
    v_mul_f32 v40, v40, v248
    v_mfma_f32_16x16x32_bf16 v[68:71], a[100:103], v[148:151], v[68:71]
    ds_read_b128 a[76:79], v10 offset:17408
    s_waitcnt lgkmcnt(15)
    v_mul_f32 v41, v41, v248
    v_mfma_f32_16x16x32_bf16 v[56:59], a[104:107], v[152:155], v[56:59]
    ds_read_b128 a[80:83], v10 offset:29696
    v_mul_f32 v42, v42, v248
    v_mfma_f32_16x16x32_bf16 v[60:63], a[104:107], v[156:159], v[60:63]
    ds_read_b128 a[84:87], v11 offset:5120
    v_mul_f32 v43, v43, v248
    v_mfma_f32_16x16x32_bf16 v[64:67], a[104:107], v[160:163], v[64:67]
    ds_read_b128 a[88:91], v11 offset:17408
    v_cvt_pk_bf16_f32 v90, v40, v41
    v_mfma_f32_16x16x32_bf16 v[68:71], a[104:107], v[164:167], v[68:71]
    ds_read_b128 a[92:95], v11 offset:29696
    v_cvt_pk_bf16_f32 v91, v42, v43
    v_mfma_f32_16x16x32_bf16 v[56:59], a[108:111], v[168:171], v[56:59]
    v_permlane16_swap_b32 v88, v90
    v_mfma_f32_16x16x32_bf16 v[60:63], a[108:111], v[172:175], v[60:63]
    v_permlane16_swap_b32 v89, v91
    v_mfma_f32_16x16x32_bf16 v[64:67], a[108:111], v[176:179], v[64:67]
    buffer_store_dwordx4 v[88:91], v21, s[56:59], s66 offen offset:64 sc1
    v_mul_f32 v28, v28, v249
    v_mfma_f32_16x16x32_bf16 v[68:71], a[108:111], v[180:183], v[68:71]
    v_mul_f32 v29, v29, v249
    v_mul_f32 v30, v30, v249
    v_mfma_f32_16x16x32_bf16 v[56:59], a[112:115], v[184:187], v[56:59]
    v_mul_f32 v31, v31, v249
    v_cvt_pk_bf16_f32 v92, v28, v29
    v_mfma_f32_16x16x32_bf16 v[60:63], a[112:115], v[188:191], v[60:63]
    v_cvt_pk_bf16_f32 v93, v30, v31
    v_mul_f32 v44, v44, v249
    v_mfma_f32_16x16x32_bf16 v[64:67], a[112:115], v[192:195], v[64:67]
    v_mul_f32 v45, v45, v249
    v_mul_f32 v46, v46, v249
    v_mfma_f32_16x16x32_bf16 v[68:71], a[112:115], v[196:199], v[68:71]
    s_waitcnt lgkmcnt(15)
    v_mul_f32 v47, v47, v249
    v_cvt_pk_bf16_f32 v94, v44, v45
    v_mfma_f32_16x16x32_bf16 v[56:59], a[116:119], v[200:203], v[56:59]
    v_cvt_pk_bf16_f32 v95, v46, v47
    v_mfma_f32_16x16x32_bf16 v[60:63], a[116:119], v[204:207], v[60:63]
    v_permlane16_swap_b32 v92, v94
    v_mfma_f32_16x16x32_bf16 v[64:67], a[116:119], v[208:211], v[64:67]
    v_permlane16_swap_b32 v93, v95
    v_mfma_f32_16x16x32_bf16 v[68:71], a[116:119], v[212:215], v[68:71]
    buffer_store_dwordx4 v[92:95], v21, s[56:59], s67 offen offset:64 sc1
    v_mul_f32 v32, v32, v250
    v_mfma_f32_16x16x32_bf16 v[72:75], a[120:123], v[120:123], 0
    v_mul_f32 v33, v33, v250
    v_mul_f32 v34, v34, v250
    v_mfma_f32_16x16x32_bf16 v[76:79], a[120:123], v[124:127], 0
    v_mul_f32 v35, v35, v250
    v_cvt_pk_bf16_f32 v96, v32, v33
    v_mfma_f32_16x16x32_bf16 v[80:83], a[120:123], v[128:131], 0
    v_cvt_pk_bf16_f32 v97, v34, v35
    v_mul_f32 v48, v48, v250
    v_mfma_f32_16x16x32_bf16 v[84:87], a[120:123], v[132:135], 0
    v_mul_f32 v49, v49, v250
    v_mul_f32 v50, v50, v250
    v_mfma_f32_16x16x32_bf16 v[72:75], a[124:127], v[136:139], v[72:75]
    v_mul_f32 v51, v51, v250
    v_cvt_pk_bf16_f32 v98, v48, v49
    v_mfma_f32_16x16x32_bf16 v[76:79], a[124:127], v[140:143], v[76:79]
    v_cvt_pk_bf16_f32 v99, v50, v51
    v_mfma_f32_16x16x32_bf16 v[80:83], a[124:127], v[144:147], v[80:83]
    v_permlane16_swap_b32 v96, v98
    v_mfma_f32_16x16x32_bf16 v[84:87], a[124:127], v[148:151], v[84:87]
    v_permlane16_swap_b32 v97, v99
    v_mfma_f32_16x16x32_bf16 v[72:75], a[128:131], v[152:155], v[72:75]
    buffer_store_dwordx4 v[96:99], v21, s[56:59], s68 offen offset:64 sc1
    v_mul_f32 v36, v36, v251
    v_mfma_f32_16x16x32_bf16 v[76:79], a[128:131], v[156:159], v[76:79]
    v_mul_f32 v37, v37, v251
    v_mul_f32 v38, v38, v251
    v_mfma_f32_16x16x32_bf16 v[80:83], a[128:131], v[160:163], v[80:83]
    v_mul_f32 v39, v39, v251
    v_cvt_pk_bf16_f32 v100, v36, v37
    v_mfma_f32_16x16x32_bf16 v[84:87], a[128:131], v[164:167], v[84:87]
    s_waitcnt lgkmcnt(14)
    v_cvt_pk_bf16_f32 v101, v38, v39
    v_mul_f32 v52, v52, v251
    v_mfma_f32_16x16x32_bf16 v[72:75], a[132:135], v[168:171], v[72:75]
    v_mul_f32 v53, v53, v251
    v_mul_f32 v54, v54, v251
    v_mfma_f32_16x16x32_bf16 v[76:79], a[132:135], v[172:175], v[76:79]
    v_mul_f32 v55, v55, v251
    v_cvt_pk_bf16_f32 v102, v52, v53
    v_mfma_f32_16x16x32_bf16 v[80:83], a[132:135], v[176:179], v[80:83]
    v_cvt_pk_bf16_f32 v103, v54, v55
    v_mfma_f32_16x16x32_bf16 v[84:87], a[132:135], v[180:183], v[84:87]
    s_waitcnt lgkmcnt(13)
    v_permlane16_swap_b32 v100, v102
    v_mfma_f32_16x16x32_bf16 v[72:75], a[136:139], v[184:187], v[72:75]
    v_permlane16_swap_b32 v101, v103
    v_mfma_f32_16x16x32_bf16 v[76:79], a[136:139], v[188:191], v[76:79]
    buffer_store_dwordx4 v[100:103], v21, s[56:59], s69 offen offset:64 sc1
    v_mfma_f32_16x16x32_bf16 v[80:83], a[136:139], v[192:195], v[80:83]
    v_mfma_f32_16x16x32_bf16 v[84:87], a[136:139], v[196:199], v[84:87]
    s_waitcnt lgkmcnt(12)
    v_mfma_f32_16x16x32_bf16 v[72:75], a[140:143], v[200:203], v[72:75]
    v_mfma_f32_16x16x32_bf16 v[76:79], a[140:143], v[204:207], v[76:79]
    v_mfma_f32_16x16x32_bf16 v[80:83], a[140:143], v[208:211], v[80:83]
    v_mfma_f32_16x16x32_bf16 v[84:87], a[140:143], v[212:215], v[84:87]
    v_add_u32 v10, 4096, v10
    v_add_u32 v11, 4096, v11
    v_add_u32 v21, 128, v21
    s_add_u32 s63, s63, 1
    s_cmp_lt_u32 s63, 3
    s_waitcnt lgkmcnt(0)
    s_cbranch_scc1 L_FINL
    v_mul_f32 v56, v56, v248
    v_mul_f32 v57, v57, v248
    v_mul_f32 v58, v58, v248
    v_mul_f32 v59, v59, v248
    v_cvt_pk_bf16_f32 v104, v56, v57
    v_cvt_pk_bf16_f32 v105, v58, v59
    v_mul_f32 v72, v72, v248
    v_mul_f32 v73, v73, v248
    v_mul_f32 v74, v74, v248
    v_mul_f32 v75, v75, v248
    v_cvt_pk_bf16_f32 v106, v72, v73
    v_cvt_pk_bf16_f32 v107, v74, v75
    s_nop 0
    v_permlane16_swap_b32 v104, v106
    v_permlane16_swap_b32 v105, v107
    buffer_store_dwordx4 v[104:107], v21, s[56:59], s66 offen offset:0 sc1
    v_mul_f32 v60, v60, v249
    v_mul_f32 v61, v61, v249
    v_mul_f32 v62, v62, v249
    v_mul_f32 v63, v63, v249
    v_cvt_pk_bf16_f32 v108, v60, v61
    v_cvt_pk_bf16_f32 v109, v62, v63
    v_mul_f32 v76, v76, v249
    v_mul_f32 v77, v77, v249
    v_mul_f32 v78, v78, v249
    v_mul_f32 v79, v79, v249
    v_cvt_pk_bf16_f32 v110, v76, v77
    v_cvt_pk_bf16_f32 v111, v78, v79
    s_nop 0
    v_permlane16_swap_b32 v108, v110
    v_permlane16_swap_b32 v109, v111
    buffer_store_dwordx4 v[108:111], v21, s[56:59], s67 offen offset:0 sc1
    v_mul_f32 v64, v64, v250
    v_mul_f32 v65, v65, v250
    v_mul_f32 v66, v66, v250
    v_mul_f32 v67, v67, v250
    v_cvt_pk_bf16_f32 v112, v64, v65
    v_cvt_pk_bf16_f32 v113, v66, v67
    v_mul_f32 v80, v80, v250
    v_mul_f32 v81, v81, v250
    v_mul_f32 v82, v82, v250
    v_mul_f32 v83, v83, v250
    v_cvt_pk_bf16_f32 v114, v80, v81
    v_cvt_pk_bf16_f32 v115, v82, v83
    s_nop 0
    v_permlane16_swap_b32 v112, v114
    v_permlane16_swap_b32 v113, v115
    buffer_store_dwordx4 v[112:115], v21, s[56:59], s68 offen offset:0 sc1
    v_mul_f32 v68, v68, v251
    v_mul_f32 v69, v69, v251
    v_mul_f32 v70, v70, v251
    v_mul_f32 v71, v71, v251
    v_cvt_pk_bf16_f32 v116, v68, v69
    v_cvt_pk_bf16_f32 v117, v70, v71
    v_mul_f32 v84, v84, v251
    v_mul_f32 v85, v85, v251
    v_mul_f32 v86, v86, v251
    v_mul_f32 v87, v87, v251
    v_cvt_pk_bf16_f32 v118, v84, v85
    v_cvt_pk_bf16_f32 v119, v86, v87
    s_nop 0
    v_permlane16_swap_b32 v116, v118
    v_permlane16_swap_b32 v117, v119
    buffer_store_dwordx4 v[116:119], v21, s[56:59], s69 offen offset:0 sc1
L_END:
    s_endpgm
.section .rodata,"a"
.p2align 6
.amdhsa_kernel standalone__linear_kernel_performer__prompt_kernel
  .amdhsa_next_free_vgpr 416
  .amdhsa_next_free_sgpr 102
  .amdhsa_accum_offset 256
  .amdhsa_group_segment_fixed_size 0
  .amdhsa_kernarg_size 56
  .amdhsa_user_sgpr_count 2
  .amdhsa_user_sgpr_kernarg_segment_ptr 1
  .amdhsa_system_sgpr_workgroup_id_x 1
.end_amdhsa_kernel
```
